```python
import torch

def _softmax(x, axis=-1):
    return torch.softmax(x, dim=axis)

def _gelu(x):
    return torch.nn.functional.gelu(x, approximate='tanh')

def _silu(x):
    return torch.nn.functional.silu(x)

def _sigmoid(x):
    return torch.sigmoid(x)

def _layernorm(x, axis=-1, eps=1e-05):
    m = x.mean(dim=axis, keepdim=True)
    v = x.var(dim=axis, keepdim=True, unbiased=False)
    return (x - m) / torch.sqrt(v + eps)

def _scatter_add(tgt, idx, src, axis=0):
    return tgt.clone().index_add_(axis, idx, src)

def _segment_sum(src, seg, n):
    out = torch.zeros((n,) + src.shape[1:], dtype=src.dtype)
    return out.index_add_(0, seg, src)

def _pad(x, pw):
    flat = tuple((v for pair in reversed(pw) for v in pair))
    return torch.nn.functional.pad(x, flat)
kernel_name = 'adaLN_cond__mha_block_cached__geglu_ffn__decode'

def setup_inputs():

    _w = lambda a: (lambda t: t.to(torch.bfloat16) if t.is_floating_point() else t)(torch.as_tensor(a))

    def _A_setup():
        B, Sq, D = (4, 1, 512)
        H, Sk, Dh = (32, 4096, 128)
        return {'x': _w((lambda *s: torch.randn(*s, dtype=torch.bfloat16) * 0.1)(B, Sq, D)), 'k_cache': _w((lambda *s: torch.randn(*s, dtype=torch.bfloat16) * 0.8)(B, H, Sk, Dh)), 'v_cache': _w((lambda *s: torch.randn(*s, dtype=torch.bfloat16) * 0.8)(B, H, Sk, Dh)), 'wq': _w((lambda *s: torch.randn(*s, dtype=torch.bfloat16) * 0.8)(D, H * Dh) * D ** (-0.5)), 'wo': _w((lambda *s: torch.randn(*s, dtype=torch.bfloat16) * 0.8)(H * Dh, D) * (H * Dh) ** (-0.5))}
    _A_in = _A_setup()

    def _B_setup():
        B, S, D, F = (4, 1, 512, 1792)
        return {'x': _w((lambda *s: torch.randn(*s, dtype=torch.bfloat16) * 0.1)(B, S, D)), 'w_gate': _w((lambda *s: torch.randn(*s, dtype=torch.bfloat16) * 0.1)(D, F)), 'w_up': _w((lambda *s: torch.randn(*s, dtype=torch.bfloat16) * 0.1)(D, F)), 'w_down': _w((lambda *s: torch.randn(*s, dtype=torch.bfloat16) * 0.1)(F, D))}
    _B_in = _B_setup()
    return {'A_x': _A_in['x'], 'A_k_cache': _A_in['k_cache'], 'A_v_cache': _A_in['v_cache'], 'A_wq': _A_in['wq'], 'A_wo': _A_in['wo'], 'B_x': _B_in['x'], 'B_w_gate': _B_in['w_gate'], 'B_w_up': _B_in['w_up'], 'B_w_down': _B_in['w_down'], 'c': _w((lambda *s: torch.randn(*s, dtype=torch.bfloat16) * 0.8)(4, 512) * 8.0), 'w_mod': _w((lambda *s: torch.randn(*s, dtype=torch.bfloat16) * 0.8)(512, 6 * 512) * 512 ** (-0.5) * 8.0)}

def reference(A_x, A_k_cache, A_v_cache, A_wq, A_wo, B_x, B_w_gate, B_w_up, B_w_down, c, w_mod):

    def _A_ref(x, k_cache, v_cache, wq, wo):
        B, Sq, D = x.shape
        H, Dh = (32, 128)
        q = (lambda x, *d: x.permute(*d))((x @ wq).reshape(B, Sq, H, Dh), 0, 2, 1, 3)
        scores = torch.einsum('bhqd,bhkd->bhqk', q, k_cache) * Dh ** (-0.5)
        p = _softmax(scores, axis=-1)
        o = torch.einsum('bhqk,bhkd->bhqd', p, v_cache)
        return (lambda x, *d: x.permute(*d))(o, 0, 2, 1, 3).reshape(B, Sq, H * Dh) @ wo

    def _B_ref(x, w_gate, w_up, w_down):
        return _gelu(x @ w_gate) * (x @ w_up) @ w_down
    x = A_x
    mod = (_silu(c) @ w_mod).reshape(c.shape[0], 6, 1, -1)
    sa, ca, ga, sb, cb, gb = (mod[:, 0].clone(), mod[:, 1].clone(), mod[:, 2].clone(), mod[:, 3].clone(), mod[:, 4].clone(), mod[:, 5].clone())
    h = _layernorm(x, axis=-1) * (1 + ca) + sa
    x = x + ga * _A_ref(h, A_k_cache, A_v_cache, A_wq, A_wo)
    h = _layernorm(x, axis=-1) * (1 + cb) + sb
    x = x + gb * _B_ref(h, B_w_gate, B_w_up, B_w_down)
    return x
```

```asm
; @launch kernel=adaln_pre_kernel grid=(96,1,1) block=(1024,1,1) lds=16384
; @launch kernel=adaLN_cond__mha_block_cached__geglu_ffn__decode_kernel grid=(256,1,1) block=(1024,1,1) lds=148480
.amdgcn_target "amdgcn-amd-amdhsa--gfx950"
.text
.globl adaln_pre_kernel
.p2align 8
.type adaln_pre_kernel,@function
adaln_pre_kernel:
  s_cmp_ge_u32 s2, 96
  s_cbranch_scc1 L_PRE_END
  s_load_dwordx4 s[16:19], s[0:1], 72
  s_load_dwordx2 s[20:21], s[0:1], 104
  v_lshrrev_b32 v1, 6, v0
  s_nop 0
  v_readfirstlane_b32 s3, v1
  v_and_b32 v1, 63, v0
  v_lshlrev_b32 v2, 4, v1
  v_lshrrev_b32 v3, 4, v1
  s_waitcnt lgkmcnt(0)
  s_mov_b32 s76, s16
  s_and_b32 s77, s17, 0xffff
  s_mov_b32 s78, 0x1000
  s_mov_b32 s79, 0x00020000
  s_mov_b32 s80, s18
  s_and_b32 s81, s19, 0xffff
  s_mov_b32 s82, 0x300000
  s_mov_b32 s83, 0x00020000
  s_mov_b32 s92, s20
  s_and_b32 s93, s21, 0xffff
  s_mov_b32 s94, 0x1000000
  s_mov_b32 s95, 0x00020000
  v_lshlrev_b32 v120, 2, v0
  buffer_load_dword v121, v120, s[76:79], 0 offen
  v_mul_u32_u24 v120, 6144, v3
  v_and_b32 v4, 15, v1
  v_lshl_add_u32 v120, v4, 2, v120
  s_mul_i32 s16, s3, 196608
  s_lshl_b32 s17, s2, 6
  s_add_u32 s16, s16, s17
  s_add_u32 s17, s16, 0
  buffer_load_dword v112, v120, s[80:83], s17 offen
  s_add_u32 s17, s16, 24576
  buffer_load_dword v113, v120, s[80:83], s17 offen
  s_add_u32 s17, s16, 49152
  buffer_load_dword v114, v120, s[80:83], s17 offen
  s_add_u32 s17, s16, 73728
  buffer_load_dword v115, v120, s[80:83], s17 offen
  s_add_u32 s17, s16, 98304
  buffer_load_dword v116, v120, s[80:83], s17 offen
  s_add_u32 s17, s16, 122880
  buffer_load_dword v117, v120, s[80:83], s17 offen
  s_add_u32 s17, s16, 147456
  buffer_load_dword v118, v120, s[80:83], s17 offen
  s_add_u32 s17, s16, 172032
  buffer_load_dword v119, v120, s[80:83], s17 offen
  s_waitcnt vmcnt(8)
  v_lshlrev_b32 v122, 16, v121
  v_and_b32 v123, 0xffff0000, v121
  v_mul_f32 v124, 0xbfb8aa3b, v122
  v_min_f32 v124, 0x42fc0000, v124
  v_exp_f32 v124, v124
  s_nop 0
  v_add_f32 v124, 1.0, v124
  v_rcp_f32 v125, v124
  s_nop 0
  v_fma_f32 v126, -v124, v125, 1.0
  v_fma_f32 v125, v126, v125, v125
  v_mul_f32 v122, v122, v125
  v_cvt_pk_bf16_f32 v122, v122, v122
  v_and_b32 v122, 0xffff0000, v122
  v_mul_f32 v124, 0xbfb8aa3b, v123
  v_min_f32 v124, 0x42fc0000, v124
  v_exp_f32 v124, v124
  s_nop 0
  v_add_f32 v124, 1.0, v124
  v_rcp_f32 v125, v124
  s_nop 0
  v_fma_f32 v126, -v124, v125, 1.0
  v_fma_f32 v125, v126, v125, v125
  v_mul_f32 v123, v123, v125
  v_cvt_pk_bf16_f32 v123, v123, v123
  v_and_b32 v123, 0xffff0000, v123
  v_and_b32 v124, 255, v0
  v_lshlrev_b32 v124, 5, v124
  v_lshrrev_b32 v125, 8, v0
  v_lshl_add_u32 v124, v125, 2, v124
  ds_write_b32 v124, v122
  ds_write_b32 v124, v123 offset:16
  s_waitcnt lgkmcnt(0)
  s_barrier
  v_mov_b32 v4, 0
  v_mov_b32 v5, 0
  v_mov_b32 v6, 0
  v_mov_b32 v7, 0
  v_mov_b32 v8, 0
  v_mov_b32 v9, 0
  v_mov_b32 v10, 0
  v_mov_b32 v11, 0
  s_lshl_b32 s16, s3, 9
  v_lshlrev_b32 v124, 4, v3
  v_add_u32 v124, s16, v124
  ds_read_b128 v[12:15], v124 offset:0
  s_waitcnt vmcnt(7)
  v_lshlrev_b32 v122, 16, v112
  v_and_b32 v123, 0xffff0000, v112
  s_waitcnt lgkmcnt(0)
  v_fmac_f32 v4, v12, v122
  v_fmac_f32 v5, v12, v123
  v_fmac_f32 v6, v13, v122
  v_fmac_f32 v7, v13, v123
  v_fmac_f32 v8, v14, v122
  v_fmac_f32 v9, v14, v123
  v_fmac_f32 v10, v15, v122
  v_fmac_f32 v11, v15, v123
  ds_read_b128 v[12:15], v124 offset:64
  s_waitcnt vmcnt(6)
  v_lshlrev_b32 v122, 16, v113
  v_and_b32 v123, 0xffff0000, v113
  s_waitcnt lgkmcnt(0)
  v_fmac_f32 v4, v12, v122
  v_fmac_f32 v5, v12, v123
  v_fmac_f32 v6, v13, v122
  v_fmac_f32 v7, v13, v123
  v_fmac_f32 v8, v14, v122
  v_fmac_f32 v9, v14, v123
  v_fmac_f32 v10, v15, v122
  v_fmac_f32 v11, v15, v123
  ds_read_b128 v[12:15], v124 offset:128
  s_waitcnt vmcnt(5)
  v_lshlrev_b32 v122, 16, v114
  v_and_b32 v123, 0xffff0000, v114
  s_waitcnt lgkmcnt(0)
  v_fmac_f32 v4, v12, v122
  v_fmac_f32 v5, v12, v123
  v_fmac_f32 v6, v13, v122
  v_fmac_f32 v7, v13, v123
  v_fmac_f32 v8, v14, v122
  v_fmac_f32 v9, v14, v123
  v_fmac_f32 v10, v15, v122
  v_fmac_f32 v11, v15, v123
  ds_read_b128 v[12:15], v124 offset:192
  s_waitcnt vmcnt(4)
  v_lshlrev_b32 v122, 16, v115
  v_and_b32 v123, 0xffff0000, v115
  s_waitcnt lgkmcnt(0)
  v_fmac_f32 v4, v12, v122
  v_fmac_f32 v5, v12, v123
  v_fmac_f32 v6, v13, v122
  v_fmac_f32 v7, v13, v123
  v_fmac_f32 v8, v14, v122
  v_fmac_f32 v9, v14, v123
  v_fmac_f32 v10, v15, v122
  v_fmac_f32 v11, v15, v123
  ds_read_b128 v[12:15], v124 offset:256
  s_waitcnt vmcnt(3)
  v_lshlrev_b32 v122, 16, v116
  v_and_b32 v123, 0xffff0000, v116
  s_waitcnt lgkmcnt(0)
  v_fmac_f32 v4, v12, v122
  v_fmac_f32 v5, v12, v123
  v_fmac_f32 v6, v13, v122
  v_fmac_f32 v7, v13, v123
  v_fmac_f32 v8, v14, v122
  v_fmac_f32 v9, v14, v123
  v_fmac_f32 v10, v15, v122
  v_fmac_f32 v11, v15, v123
  ds_read_b128 v[12:15], v124 offset:320
  s_waitcnt vmcnt(2)
  v_lshlrev_b32 v122, 16, v117
  v_and_b32 v123, 0xffff0000, v117
  s_waitcnt lgkmcnt(0)
  v_fmac_f32 v4, v12, v122
  v_fmac_f32 v5, v12, v123
  v_fmac_f32 v6, v13, v122
  v_fmac_f32 v7, v13, v123
  v_fmac_f32 v8, v14, v122
  v_fmac_f32 v9, v14, v123
  v_fmac_f32 v10, v15, v122
  v_fmac_f32 v11, v15, v123
  ds_read_b128 v[12:15], v124 offset:384
  s_waitcnt vmcnt(1)
  v_lshlrev_b32 v122, 16, v118
  v_and_b32 v123, 0xffff0000, v118
  s_waitcnt lgkmcnt(0)
  v_fmac_f32 v4, v12, v122
  v_fmac_f32 v5, v12, v123
  v_fmac_f32 v6, v13, v122
  v_fmac_f32 v7, v13, v123
  v_fmac_f32 v8, v14, v122
  v_fmac_f32 v9, v14, v123
  v_fmac_f32 v10, v15, v122
  v_fmac_f32 v11, v15, v123
  ds_read_b128 v[12:15], v124 offset:448
  s_waitcnt vmcnt(0)
  v_lshlrev_b32 v122, 16, v119
  v_and_b32 v123, 0xffff0000, v119
  s_waitcnt lgkmcnt(0)
  v_fmac_f32 v4, v12, v122
  v_fmac_f32 v5, v12, v123
  v_fmac_f32 v6, v13, v122
  v_fmac_f32 v7, v13, v123
  v_fmac_f32 v8, v14, v122
  v_fmac_f32 v9, v14, v123
  v_fmac_f32 v10, v15, v122
  v_fmac_f32 v11, v15, v123
  v_mov_b32 v120, v4
  v_mov_b32 v121, v5
  v_mov_b32 v122, v6
  v_mov_b32 v123, v7
  v_mov_b32 v124, v8
  v_mov_b32 v125, v9
  v_mov_b32 v126, v10
  v_mov_b32 v127, v11
  v_permlane16_swap_b32 v4, v120
  v_permlane16_swap_b32 v5, v121
  v_permlane16_swap_b32 v6, v122
  v_permlane16_swap_b32 v7, v123
  v_permlane16_swap_b32 v8, v124
  v_permlane16_swap_b32 v9, v125
  v_permlane16_swap_b32 v10, v126
  v_permlane16_swap_b32 v11, v127
  v_add_f32 v4, v4, v120
  v_add_f32 v5, v5, v121
  v_add_f32 v6, v6, v122
  v_add_f32 v7, v7, v123
  v_add_f32 v8, v8, v124
  v_add_f32 v9, v9, v125
  v_add_f32 v10, v10, v126
  v_add_f32 v11, v11, v127
  v_mov_b32 v120, v4
  v_mov_b32 v121, v5
  v_mov_b32 v122, v6
  v_mov_b32 v123, v7
  v_mov_b32 v124, v8
  v_mov_b32 v125, v9
  v_mov_b32 v126, v10
  v_mov_b32 v127, v11
  v_permlane32_swap_b32 v4, v120
  v_permlane32_swap_b32 v5, v121
  v_permlane32_swap_b32 v6, v122
  v_permlane32_swap_b32 v7, v123
  v_permlane32_swap_b32 v8, v124
  v_permlane32_swap_b32 v9, v125
  v_permlane32_swap_b32 v10, v126
  v_permlane32_swap_b32 v11, v127
  v_add_f32 v4, v4, v120
  v_add_f32 v5, v5, v121
  v_add_f32 v6, v6, v122
  v_add_f32 v7, v7, v123
  v_add_f32 v8, v8, v124
  v_add_f32 v9, v9, v125
  v_add_f32 v10, v10, v126
  v_add_f32 v11, v11, v127
  v_and_b32 v124, 15, v1
  v_lshlrev_b32 v124, 3, v124
  s_lshl_b32 s16, s3, 9
  s_add_u32 s16, s16, 8192
  v_add_u32 v124, s16, v124
  ds_write_b64 v124, v[4:5] offset:0
  ds_write_b64 v124, v[6:7] offset:128
  ds_write_b64 v124, v[8:9] offset:256
  ds_write_b64 v124, v[10:11] offset:384
  s_waitcnt lgkmcnt(0)
  s_barrier
  s_cmp_eq_u32 s3, 0
  s_cbranch_scc0 L_PRE_END
  v_lshlrev_b32 v124, 7, v3
  v_and_b32 v125, 15, v1
  v_lshl_add_u32 v124, v125, 3, v124
  v_add_u32 v124, 8192, v124
  ds_read_b64 v[4:5], v124
  ds_read_b64 v[10:11], v124 offset:512
  ds_read_b64 v[12:13], v124 offset:1024
  ds_read_b64 v[14:15], v124 offset:1536
  ds_read_b64 v[8:9], v124 offset:2048
  s_waitcnt lgkmcnt(0)
  v_add_f32 v4, v4, v10
  v_add_f32 v5, v5, v11
  v_add_f32 v4, v4, v12
  v_add_f32 v5, v5, v13
  v_add_f32 v4, v4, v14
  v_add_f32 v5, v5, v15
  v_add_f32 v4, v4, v8
  v_add_f32 v5, v5, v9
  ds_read_b64 v[10:11], v124 offset:2560
  ds_read_b64 v[12:13], v124 offset:3072
  ds_read_b64 v[14:15], v124 offset:3584
  ds_read_b64 v[8:9], v124 offset:4096
  s_waitcnt lgkmcnt(0)
  v_add_f32 v4, v4, v10
  v_add_f32 v5, v5, v11
  v_add_f32 v4, v4, v12
  v_add_f32 v5, v5, v13
  v_add_f32 v4, v4, v14
  v_add_f32 v5, v5, v15
  v_add_f32 v4, v4, v8
  v_add_f32 v5, v5, v9
  ds_read_b64 v[10:11], v124 offset:4608
  ds_read_b64 v[12:13], v124 offset:5120
  ds_read_b64 v[14:15], v124 offset:5632
  ds_read_b64 v[8:9], v124 offset:6144
  s_waitcnt lgkmcnt(0)
  v_add_f32 v4, v4, v10
  v_add_f32 v5, v5, v11
  v_add_f32 v4, v4, v12
  v_add_f32 v5, v5, v13
  v_add_f32 v4, v4, v14
  v_add_f32 v5, v5, v15
  v_add_f32 v4, v4, v8
  v_add_f32 v5, v5, v9
  ds_read_b64 v[10:11], v124 offset:6656
  ds_read_b64 v[12:13], v124 offset:7168
  ds_read_b64 v[14:15], v124 offset:7680
  s_waitcnt lgkmcnt(0)
  v_add_f32 v4, v4, v10
  v_add_f32 v5, v5, v11
  v_add_f32 v4, v4, v12
  v_add_f32 v5, v5, v13
  v_add_f32 v4, v4, v14
  v_add_f32 v5, v5, v15
  v_cvt_pk_bf16_f32 v4, v4, v5
  v_mul_u32_u24 v124, 6144, v3
  v_lshl_add_u32 v124, v125, 2, v124
  s_lshl_b32 s16, s2, 6
  buffer_store_dword v4, v124, s[92:95], s16 offen
  v_mov_b32 v8, 0
  v_mov_b32 v9, 0
  v_mov_b32 v10, 0
  v_mov_b32 v11, 0
  s_lshl_b32 s16, s2, 9
  s_add_u32 s16, s16, 32768
  s_mov_b64 exec, 0xffffffff
  buffer_store_dwordx4 v[8:11], v2, s[92:95], s16 offen
  s_mov_b64 exec, -1
L_PRE_END:
  s_endpgm
.globl adaLN_cond__mha_block_cached__geglu_ffn__decode_kernel
.p2align 8
.type adaLN_cond__mha_block_cached__geglu_ffn__decode_kernel,@function
adaLN_cond__mha_block_cached__geglu_ffn__decode_kernel:
  s_cmp_ge_u32 s2, 256
  s_cbranch_scc1 L_END
  s_load_dwordx16 s[16:31], s[0:1], 0
  s_load_dwordx8 s[32:39], s[0:1], 64
  s_load_dwordx4 s[40:43], s[0:1], 96
  v_lshrrev_b32 v1, 6, v0
  s_nop 0
  v_readfirstlane_b32 s3, v1
  v_and_b32 v1, 63, v0
  v_lshlrev_b32 v2, 4, v1
  s_and_b32 s97, s2, 7
  s_lshr_b32 s4, s2, 3
  s_and_b32 s98, s4, 1
  s_lshr_b32 s5, s4, 1
  s_and_b32 s96, s5, 3
  s_lshr_b32 s5, s4, 3
  s_lshl_b32 s5, s5, 3
  s_or_b32 s97, s97, s5
  s_waitcnt lgkmcnt(0)
  s_mov_b32 s44, s16
  s_and_b32 s45, s17, 0xffff
  s_mov_b32 s46, 0x1000
  s_mov_b32 s47, 0x00020000
  s_mov_b32 s48, s18
  s_and_b32 s49, s19, 0xffff
  s_mov_b32 s50, 0x8000000
  s_mov_b32 s51, 0x00020000
  s_mov_b32 s52, s20
  s_and_b32 s53, s21, 0xffff
  s_mov_b32 s54, 0x8000000
  s_mov_b32 s55, 0x00020000
  s_mov_b32 s56, s22
  s_and_b32 s57, s23, 0xffff
  s_mov_b32 s58, 0x400000
  s_mov_b32 s59, 0x00020000
  s_mov_b32 s60, s24
  s_and_b32 s61, s25, 0xffff
  s_mov_b32 s62, 0x400000
  s_mov_b32 s63, 0x00020000
  s_mov_b32 s64, s28
  s_and_b32 s65, s29, 0xffff
  s_mov_b32 s66, 0x1c0000
  s_mov_b32 s67, 0x00020000
  s_mov_b32 s68, s30
  s_and_b32 s69, s31, 0xffff
  s_mov_b32 s70, 0x1c0000
  s_mov_b32 s71, 0x00020000
  s_mov_b32 s72, s32
  s_and_b32 s73, s33, 0xffff
  s_mov_b32 s74, 0x1c0000
  s_mov_b32 s75, 0x00020000
  s_mov_b32 s76, s34
  s_and_b32 s77, s35, 0xffff
  s_mov_b32 s78, 0x1000
  s_mov_b32 s79, 0x00020000
  s_mov_b32 s80, s36
  s_and_b32 s81, s37, 0xffff
  s_mov_b32 s82, 0x300000
  s_mov_b32 s83, 0x00020000
  s_mov_b32 s84, s38
  s_and_b32 s85, s39, 0xffff
  s_mov_b32 s86, 0x1000
  s_mov_b32 s87, 0x00020000
  s_mov_b32 s88, s40
  s_and_b32 s89, s41, 0xffff
  s_mov_b32 s90, 0x100
  s_mov_b32 s91, 0x00020000
  s_mov_b32 s92, s42
  s_and_b32 s93, s43, 0xffff
  s_mov_b32 s94, 0x1000000
  s_mov_b32 s95, 0x00020000
  s_lshl_b32 s4, s96, 5
  s_add_u32 s4, s4, s97
  s_lshl_b32 s4, s4, 20
  s_lshl_b32 s5, s98, 19
  s_add_u32 s4, s4, s5
  s_lshl_b32 s5, s3, 15
  s_add_u32 s99, s4, s5
  v_lshrrev_b32 v3, 4, v1
  s_lshl_b32 s16, s96, 10
  buffer_load_dwordx4 v[112:115], v2, s[44:47], s16 offen
  s_mul_i32 s16, s96, 6144
  buffer_load_dwordx4 v[116:119], v2, s[92:95], s16 offen
  buffer_load_dwordx4 v[120:123], v2, s[92:95], s16 offen offset:1024
  v_and_b32 v4, 15, v1
  v_lshlrev_b32 v124, 13, v3
  v_lshl_add_u32 v124, v4, 4, v124
  s_lshl_b32 s16, s3, 18
  s_lshl_b32 s17, s97, 8
  s_add_u32 s16, s16, s17
  s_add_u32 s17, s16, 0
  buffer_load_dwordx4 v[16:19], v124, s[56:59], s17 offen
  s_add_u32 s17, s16, 32768
  buffer_load_dwordx4 v[20:23], v124, s[56:59], s17 offen
  s_add_u32 s17, s16, 65536
  buffer_load_dwordx4 v[24:27], v124, s[56:59], s17 offen
  s_add_u32 s17, s16, 98304
  buffer_load_dwordx4 v[28:31], v124, s[56:59], s17 offen
  s_add_u32 s17, s16, 131072
  buffer_load_dwordx4 v[32:35], v124, s[56:59], s17 offen
  s_add_u32 s17, s16, 163840
  buffer_load_dwordx4 v[36:39], v124, s[56:59], s17 offen
  s_add_u32 s17, s16, 196608
  buffer_load_dwordx4 v[40:43], v124, s[56:59], s17 offen
  s_add_u32 s17, s16, 229376
  buffer_load_dwordx4 v[44:47], v124, s[56:59], s17 offen
  s_sub_u32 s18, s2, 96
  s_cmp_lt_u32 s18, 56
  s_cbranch_scc0 L_p2
  v_lshrrev_b32 v124, 2, v1
  v_mul_u32_u24 v124, 3584, v124
  v_and_b32 v125, 3, v1
  v_lshl_add_u32 v124, v125, 4, v124
  s_mul_i32 s16, s3, 114688
  s_lshl_b32 s17, s18, 6
  s_add_u32 s16, s16, s17
  s_lshl_b32 s19, s3, 11
  s_add_u32 s17, s16, 0
  s_add_u32 s21, s19, 0
  s_mov_b32 m0, s21
  s_nop 0
  buffer_load_dwordx4 v124, s[64:67], s17 offen lds
  s_add_u32 s17, s16, 57344
  s_add_u32 s21, s19, 1024
  s_mov_b32 m0, s21
  s_nop 0
  buffer_load_dwordx4 v124, s[64:67], s17 offen lds
  s_add_u32 s17, s16, 0
  s_add_u32 s21, s19, 32768
  s_mov_b32 m0, s21
  s_nop 0
  buffer_load_dwordx4 v124, s[68:71], s17 offen lds
  s_add_u32 s17, s16, 57344
  s_add_u32 s21, s19, 33792
  s_mov_b32 m0, s21
  s_nop 0
  buffer_load_dwordx4 v124, s[68:71], s17 offen lds
  s_lshl_b32 s17, s18, 15
  s_add_u32 s17, s17, s19
  s_add_u32 s22, s17, 0
  s_add_u32 s21, s19, 65536
  s_mov_b32 m0, s21
  s_nop 0
  buffer_load_dwordx4 v2, s[72:75], s22 offen lds
  s_add_u32 s22, s17, 1024
  s_add_u32 s21, s19, 66560
  s_mov_b32 m0, s21
  s_nop 0
  buffer_load_dwordx4 v2, s[72:75], s22 offen lds
L_p2:
  s_nop 1
  s_add_u32 s17, s99, 0
  buffer_load_dwordx4 v[48:51], v2, s[48:51], s17 offen nt
  s_add_u32 s17, s99, 1024
  buffer_load_dwordx4 v[52:55], v2, s[48:51], s17 offen nt
  s_add_u32 s17, s99, 2048
  buffer_load_dwordx4 v[56:59], v2, s[48:51], s17 offen nt
  s_add_u32 s17, s99, 3072
  buffer_load_dwordx4 v[60:63], v2, s[48:51], s17 offen nt
  s_add_u32 s17, s99, 4096
  buffer_load_dwordx4 v[64:67], v2, s[48:51], s17 offen nt
  s_add_u32 s17, s99, 5120
  buffer_load_dwordx4 v[68:71], v2, s[48:51], s17 offen nt
  s_waitcnt vmcnt(16)
  v_lshlrev_b32 v4, 16, v112
  v_and_b32 v5, 0xffff0000, v112
  v_lshlrev_b32 v6, 16, v113
  v_and_b32 v7, 0xffff0000, v113
  v_lshlrev_b32 v8, 16, v114
  v_and_b32 v9, 0xffff0000, v114
  v_lshlrev_b32 v10, 16, v115
  v_and_b32 v11, 0xffff0000, v115
  v_add_f32 v12, v4, v5
  v_add_f32 v12, v12, v6
  v_add_f32 v12, v12, v7
  v_add_f32 v12, v12, v8
  v_add_f32 v12, v12, v9
  v_add_f32 v12, v12, v10
  v_add_f32 v12, v12, v11
  s_nop 1
  v_add_f32_dpp v12, v12, v12 row_ror:8 row_mask:0xf bank_mask:0xf
  s_nop 1
  v_add_f32_dpp v12, v12, v12 row_ror:4 row_mask:0xf bank_mask:0xf
  s_nop 1
  v_add_f32_dpp v12, v12, v12 row_ror:2 row_mask:0xf bank_mask:0xf
  s_nop 1
  v_add_f32_dpp v12, v12, v12 row_ror:1 row_mask:0xf bank_mask:0xf
  v_mov_b32 v126, v12
  s_nop 1
  v_permlane16_swap_b32 v12, v126
  v_add_f32 v12, v12, v126
  v_mov_b32 v126, v12
  s_nop 1
  v_permlane32_swap_b32 v12, v126
  v_add_f32 v12, v12, v126
  v_mul_f32 v13, 0x3b000000, v12
  v_sub_f32 v14, v4, v13
  v_sub_f32 v15, v5, v13
  v_sub_f32 v112, v6, v13
  v_sub_f32 v113, v7, v13
  v_sub_f32 v114, v8, v13
  v_sub_f32 v115, v9, v13
  v_sub_f32 v124, v10, v13
  v_sub_f32 v125, v11, v13
  v_mul_f32 v12, v14, v14
  v_fmac_f32 v12, v15, v15
  v_fmac_f32 v12, v112, v112
  v_fmac_f32 v12, v113, v113
  v_fmac_f32 v12, v114, v114
  v_fmac_f32 v12, v115, v115
  v_fmac_f32 v12, v124, v124
  v_fmac_f32 v12, v125, v125
  s_nop 1
  v_add_f32_dpp v12, v12, v12 row_ror:8 row_mask:0xf bank_mask:0xf
  s_nop 1
  v_add_f32_dpp v12, v12, v12 row_ror:4 row_mask:0xf bank_mask:0xf
  s_nop 1
  v_add_f32_dpp v12, v12, v12 row_ror:2 row_mask:0xf bank_mask:0xf
  s_nop 1
  v_add_f32_dpp v12, v12, v12 row_ror:1 row_mask:0xf bank_mask:0xf
  v_mov_b32 v126, v12
  s_nop 1
  v_permlane16_swap_b32 v12, v126
  v_add_f32 v12, v12, v126
  v_mov_b32 v126, v12
  s_nop 1
  v_permlane32_swap_b32 v12, v126
  v_add_f32 v12, v12, v126
  v_mul_f32 v12, 0x3b000000, v12
  v_cvt_pk_bf16_f32 v12, v12, v12
  v_and_b32 v12, 0xffff0000, v12
  v_add_f32 v12, 0x3727c5ac, v12
  v_cvt_pk_bf16_f32 v12, v12, v12
  v_and_b32 v12, 0xffff0000, v12
  v_sqrt_f32 v12, v12
  s_nop 0
  v_cvt_pk_bf16_f32 v12, v12, v12
  v_and_b32 v12, 0xffff0000, v12
  v_cvt_pk_bf16_f32 v13, v13, v13
  v_and_b32 v13, 0xffff0000, v13
  v_sub_f32 v14, v4, v13
  v_sub_f32 v15, v5, v13
  v_sub_f32 v112, v6, v13
  v_sub_f32 v113, v7, v13
  v_sub_f32 v114, v8, v13
  v_sub_f32 v115, v9, v13
  v_sub_f32 v124, v10, v13
  v_sub_f32 v125, v11, v13
  v_cvt_pk_bf16_f32 v14, v14, v14
  v_and_b32 v14, 0xffff0000, v14
  v_cvt_pk_bf16_f32 v15, v15, v15
  v_and_b32 v15, 0xffff0000, v15
  v_cvt_pk_bf16_f32 v112, v112, v112
  v_and_b32 v112, 0xffff0000, v112
  v_cvt_pk_bf16_f32 v113, v113, v113
  v_and_b32 v113, 0xffff0000, v113
  v_cvt_pk_bf16_f32 v114, v114, v114
  v_and_b32 v114, 0xffff0000, v114
  v_cvt_pk_bf16_f32 v115, v115, v115
  v_and_b32 v115, 0xffff0000, v115
  v_cvt_pk_bf16_f32 v124, v124, v124
  v_and_b32 v124, 0xffff0000, v124
  v_cvt_pk_bf16_f32 v125, v125, v125
  v_and_b32 v125, 0xffff0000, v125
  v_rcp_f32 v126, v12
  s_nop 0
  v_fma_f32 v127, -v12, v126, 1.0
  v_fma_f32 v126, v127, v126, v126
  v_mul_f32 v4, v14, v126
  v_fma_f32 v127, -v4, v12, v14
  v_fma_f32 v4, v127, v126, v4
  v_rcp_f32 v126, v12
  s_nop 0
  v_fma_f32 v127, -v12, v126, 1.0
  v_fma_f32 v126, v127, v126, v126
  v_mul_f32 v5, v15, v126
  v_fma_f32 v127, -v5, v12, v15
  v_fma_f32 v5, v127, v126, v5
  v_rcp_f32 v126, v12
  s_nop 0
  v_fma_f32 v127, -v12, v126, 1.0
  v_fma_f32 v126, v127, v126, v126
  v_mul_f32 v6, v112, v126
  v_fma_f32 v127, -v6, v12, v112
  v_fma_f32 v6, v127, v126, v6
  v_rcp_f32 v126, v12
  s_nop 0
  v_fma_f32 v127, -v12, v126, 1.0
  v_fma_f32 v126, v127, v126, v126
  v_mul_f32 v7, v113, v126
  v_fma_f32 v127, -v7, v12, v113
  v_fma_f32 v7, v127, v126, v7
  v_rcp_f32 v126, v12
  s_nop 0
  v_fma_f32 v127, -v12, v126, 1.0
  v_fma_f32 v126, v127, v126, v126
  v_mul_f32 v8, v114, v126
  v_fma_f32 v127, -v8, v12, v114
  v_fma_f32 v8, v127, v126, v8
  v_rcp_f32 v126, v12
  s_nop 0
  v_fma_f32 v127, -v12, v126, 1.0
  v_fma_f32 v126, v127, v126, v126
  v_mul_f32 v9, v115, v126
  v_fma_f32 v127, -v9, v12, v115
  v_fma_f32 v9, v127, v126, v9
  v_rcp_f32 v126, v12
  s_nop 0
  v_fma_f32 v127, -v12, v126, 1.0
  v_fma_f32 v126, v127, v126, v126
  v_mul_f32 v10, v124, v126
  v_fma_f32 v127, -v10, v12, v124
  v_fma_f32 v10, v127, v126, v10
  v_rcp_f32 v126, v12
  s_nop 0
  v_fma_f32 v127, -v12, v126, 1.0
  v_fma_f32 v126, v127, v126, v126
  v_mul_f32 v11, v125, v126
  v_fma_f32 v127, -v11, v12, v125
  v_fma_f32 v11, v127, v126, v11
  v_cvt_pk_bf16_f32 v4, v4, v4
  v_and_b32 v4, 0xffff0000, v4
  v_cvt_pk_bf16_f32 v5, v5, v5
  v_and_b32 v5, 0xffff0000, v5
  v_cvt_pk_bf16_f32 v6, v6, v6
  v_and_b32 v6, 0xffff0000, v6
  v_cvt_pk_bf16_f32 v7, v7, v7
  v_and_b32 v7, 0xffff0000, v7
  v_cvt_pk_bf16_f32 v8, v8, v8
  v_and_b32 v8, 0xffff0000, v8
  v_cvt_pk_bf16_f32 v9, v9, v9
  v_and_b32 v9, 0xffff0000, v9
  v_cvt_pk_bf16_f32 v10, v10, v10
  v_and_b32 v10, 0xffff0000, v10
  v_cvt_pk_bf16_f32 v11, v11, v11
  v_and_b32 v11, 0xffff0000, v11
  s_waitcnt vmcnt(14)
  v_lshlrev_b32 v12, 16, v120
  v_and_b32 v13, 0xffff0000, v120
  v_lshlrev_b32 v14, 16, v121
  v_and_b32 v15, 0xffff0000, v121
  v_lshlrev_b32 v112, 16, v122
  v_and_b32 v113, 0xffff0000, v122
  v_lshlrev_b32 v114, 16, v123
  v_and_b32 v115, 0xffff0000, v123
  v_add_f32 v12, 1.0, v12
  v_add_f32 v13, 1.0, v13
  v_add_f32 v14, 1.0, v14
  v_add_f32 v15, 1.0, v15
  v_add_f32 v112, 1.0, v112
  v_add_f32 v113, 1.0, v113
  v_add_f32 v114, 1.0, v114
  v_add_f32 v115, 1.0, v115
  v_cvt_pk_bf16_f32 v12, v12, v12
  v_and_b32 v12, 0xffff0000, v12
  v_cvt_pk_bf16_f32 v13, v13, v13
  v_and_b32 v13, 0xffff0000, v13
  v_cvt_pk_bf16_f32 v14, v14, v14
  v_and_b32 v14, 0xffff0000, v14
  v_cvt_pk_bf16_f32 v15, v15, v15
  v_and_b32 v15, 0xffff0000, v15
  v_cvt_pk_bf16_f32 v112, v112, v112
  v_and_b32 v112, 0xffff0000, v112
  v_cvt_pk_bf16_f32 v113, v113, v113
  v_and_b32 v113, 0xffff0000, v113
  v_cvt_pk_bf16_f32 v114, v114, v114
  v_and_b32 v114, 0xffff0000, v114
  v_cvt_pk_bf16_f32 v115, v115, v115
  v_and_b32 v115, 0xffff0000, v115
  v_mul_f32 v4, v4, v12
  v_mul_f32 v5, v5, v13
  v_mul_f32 v6, v6, v14
  v_mul_f32 v7, v7, v15
  v_mul_f32 v8, v8, v112
  v_mul_f32 v9, v9, v113
  v_mul_f32 v10, v10, v114
  v_mul_f32 v11, v11, v115
  v_cvt_pk_bf16_f32 v4, v4, v4
  v_and_b32 v4, 0xffff0000, v4
  v_cvt_pk_bf16_f32 v5, v5, v5
  v_and_b32 v5, 0xffff0000, v5
  v_cvt_pk_bf16_f32 v6, v6, v6
  v_and_b32 v6, 0xffff0000, v6
  v_cvt_pk_bf16_f32 v7, v7, v7
  v_and_b32 v7, 0xffff0000, v7
  v_cvt_pk_bf16_f32 v8, v8, v8
  v_and_b32 v8, 0xffff0000, v8
  v_cvt_pk_bf16_f32 v9, v9, v9
  v_and_b32 v9, 0xffff0000, v9
  v_cvt_pk_bf16_f32 v10, v10, v10
  v_and_b32 v10, 0xffff0000, v10
  v_cvt_pk_bf16_f32 v11, v11, v11
  v_and_b32 v11, 0xffff0000, v11
  v_lshlrev_b32 v12, 16, v116
  v_and_b32 v13, 0xffff0000, v116
  v_lshlrev_b32 v14, 16, v117
  v_and_b32 v15, 0xffff0000, v117
  v_lshlrev_b32 v112, 16, v118
  v_and_b32 v113, 0xffff0000, v118
  v_lshlrev_b32 v114, 16, v119
  v_and_b32 v115, 0xffff0000, v119
  v_add_f32 v4, v4, v12
  v_add_f32 v5, v5, v13
  v_add_f32 v6, v6, v14
  v_add_f32 v7, v7, v15
  v_add_f32 v8, v8, v112
  v_add_f32 v9, v9, v113
  v_add_f32 v10, v10, v114
  v_add_f32 v11, v11, v115
  v_cvt_pk_bf16_f32 v4, v4, v4
  v_and_b32 v4, 0xffff0000, v4
  v_cvt_pk_bf16_f32 v5, v5, v5
  v_and_b32 v5, 0xffff0000, v5
  v_cvt_pk_bf16_f32 v6, v6, v6
  v_and_b32 v6, 0xffff0000, v6
  v_cvt_pk_bf16_f32 v7, v7, v7
  v_and_b32 v7, 0xffff0000, v7
  v_cvt_pk_bf16_f32 v8, v8, v8
  v_and_b32 v8, 0xffff0000, v8
  v_cvt_pk_bf16_f32 v9, v9, v9
  v_and_b32 v9, 0xffff0000, v9
  v_cvt_pk_bf16_f32 v10, v10, v10
  v_and_b32 v10, 0xffff0000, v10
  v_cvt_pk_bf16_f32 v11, v11, v11
  v_and_b32 v11, 0xffff0000, v11
  v_lshlrev_b32 v124, 5, v1
  v_add_u32 v124, 139264, v124
  ds_write_b128 v124, v[4:7]
  ds_write_b128 v124, v[8:11] offset:16
  s_waitcnt lgkmcnt(0)
  s_lshl_b32 s16, s3, 7
  s_add_u32 s16, s16, 139264
  v_lshlrev_b32 v8, 2, v3
  v_add_u32 v8, s16, v8
  ds_read_b32 v120, v8 offset:0
  ds_read_b32 v121, v8 offset:16
  ds_read_b32 v122, v8 offset:32
  ds_read_b32 v123, v8 offset:48
  ds_read_b32 v124, v8 offset:64
  ds_read_b32 v125, v8 offset:80
  ds_read_b32 v126, v8 offset:96
  ds_read_b32 v127, v8 offset:112
  v_mov_b32 v8, 0
  v_mov_b32 v9, 0
  v_mov_b32 v10, 0
  v_mov_b32 v11, 0
  v_mov_b32 v12, 0
  v_mov_b32 v13, 0
  v_mov_b32 v14, 0
  v_mov_b32 v15, 0
  s_waitcnt lgkmcnt(0)
  s_waitcnt vmcnt(13)
  v_lshlrev_b32 v112, 16, v16
  v_and_b32 v113, 0xffff0000, v16
  v_lshlrev_b32 v114, 16, v17
  v_and_b32 v115, 0xffff0000, v17
  v_lshlrev_b32 v116, 16, v18
  v_and_b32 v117, 0xffff0000, v18
  v_lshlrev_b32 v118, 16, v19
  v_and_b32 v119, 0xffff0000, v19
  v_fmac_f32 v8, v120, v112
  v_fmac_f32 v9, v120, v113
  v_fmac_f32 v10, v120, v114
  v_fmac_f32 v11, v120, v115
  v_fmac_f32 v12, v120, v116
  v_fmac_f32 v13, v120, v117
  v_fmac_f32 v14, v120, v118
  v_fmac_f32 v15, v120, v119
  s_waitcnt vmcnt(12)
  v_lshlrev_b32 v112, 16, v20
  v_and_b32 v113, 0xffff0000, v20
  v_lshlrev_b32 v114, 16, v21
  v_and_b32 v115, 0xffff0000, v21
  v_lshlrev_b32 v116, 16, v22
  v_and_b32 v117, 0xffff0000, v22
  v_lshlrev_b32 v118, 16, v23
  v_and_b32 v119, 0xffff0000, v23
  v_fmac_f32 v8, v121, v112
  v_fmac_f32 v9, v121, v113
  v_fmac_f32 v10, v121, v114
  v_fmac_f32 v11, v121, v115
  v_fmac_f32 v12, v121, v116
  v_fmac_f32 v13, v121, v117
  v_fmac_f32 v14, v121, v118
  v_fmac_f32 v15, v121, v119
  s_waitcnt vmcnt(11)
  v_lshlrev_b32 v112, 16, v24
  v_and_b32 v113, 0xffff0000, v24
  v_lshlrev_b32 v114, 16, v25
  v_and_b32 v115, 0xffff0000, v25
  v_lshlrev_b32 v116, 16, v26
  v_and_b32 v117, 0xffff0000, v26
  v_lshlrev_b32 v118, 16, v27
  v_and_b32 v119, 0xffff0000, v27
  v_fmac_f32 v8, v122, v112
  v_fmac_f32 v9, v122, v113
  v_fmac_f32 v10, v122, v114
  v_fmac_f32 v11, v122, v115
  v_fmac_f32 v12, v122, v116
  v_fmac_f32 v13, v122, v117
  v_fmac_f32 v14, v122, v118
  v_fmac_f32 v15, v122, v119
  s_waitcnt vmcnt(10)
  v_lshlrev_b32 v112, 16, v28
  v_and_b32 v113, 0xffff0000, v28
  v_lshlrev_b32 v114, 16, v29
  v_and_b32 v115, 0xffff0000, v29
  v_lshlrev_b32 v116, 16, v30
  v_and_b32 v117, 0xffff0000, v30
  v_lshlrev_b32 v118, 16, v31
  v_and_b32 v119, 0xffff0000, v31
  v_fmac_f32 v8, v123, v112
  v_fmac_f32 v9, v123, v113
  v_fmac_f32 v10, v123, v114
  v_fmac_f32 v11, v123, v115
  v_fmac_f32 v12, v123, v116
  v_fmac_f32 v13, v123, v117
  v_fmac_f32 v14, v123, v118
  v_fmac_f32 v15, v123, v119
  s_waitcnt vmcnt(9)
  v_lshlrev_b32 v112, 16, v32
  v_and_b32 v113, 0xffff0000, v32
  v_lshlrev_b32 v114, 16, v33
  v_and_b32 v115, 0xffff0000, v33
  v_lshlrev_b32 v116, 16, v34
  v_and_b32 v117, 0xffff0000, v34
  v_lshlrev_b32 v118, 16, v35
  v_and_b32 v119, 0xffff0000, v35
  v_fmac_f32 v8, v124, v112
  v_fmac_f32 v9, v124, v113
  v_fmac_f32 v10, v124, v114
  v_fmac_f32 v11, v124, v115
  v_fmac_f32 v12, v124, v116
  v_fmac_f32 v13, v124, v117
  v_fmac_f32 v14, v124, v118
  v_fmac_f32 v15, v124, v119
  s_waitcnt vmcnt(8)
  v_lshlrev_b32 v112, 16, v36
  v_and_b32 v113, 0xffff0000, v36
  v_lshlrev_b32 v114, 16, v37
  v_and_b32 v115, 0xffff0000, v37
  v_lshlrev_b32 v116, 16, v38
  v_and_b32 v117, 0xffff0000, v38
  v_lshlrev_b32 v118, 16, v39
  v_and_b32 v119, 0xffff0000, v39
  v_fmac_f32 v8, v125, v112
  v_fmac_f32 v9, v125, v113
  v_fmac_f32 v10, v125, v114
  v_fmac_f32 v11, v125, v115
  v_fmac_f32 v12, v125, v116
  v_fmac_f32 v13, v125, v117
  v_fmac_f32 v14, v125, v118
  v_fmac_f32 v15, v125, v119
  s_waitcnt vmcnt(7)
  v_lshlrev_b32 v112, 16, v40
  v_and_b32 v113, 0xffff0000, v40
  v_lshlrev_b32 v114, 16, v41
  v_and_b32 v115, 0xffff0000, v41
  v_lshlrev_b32 v116, 16, v42
  v_and_b32 v117, 0xffff0000, v42
  v_lshlrev_b32 v118, 16, v43
  v_and_b32 v119, 0xffff0000, v43
  v_fmac_f32 v8, v126, v112
  v_fmac_f32 v9, v126, v113
  v_fmac_f32 v10, v126, v114
  v_fmac_f32 v11, v126, v115
  v_fmac_f32 v12, v126, v116
  v_fmac_f32 v13, v126, v117
  v_fmac_f32 v14, v126, v118
  v_fmac_f32 v15, v126, v119
  s_waitcnt vmcnt(6)
  v_lshlrev_b32 v112, 16, v44
  v_and_b32 v113, 0xffff0000, v44
  v_lshlrev_b32 v114, 16, v45
  v_and_b32 v115, 0xffff0000, v45
  v_lshlrev_b32 v116, 16, v46
  v_and_b32 v117, 0xffff0000, v46
  v_lshlrev_b32 v118, 16, v47
  v_and_b32 v119, 0xffff0000, v47
  v_fmac_f32 v8, v127, v112
  v_fmac_f32 v9, v127, v113
  v_fmac_f32 v10, v127, v114
  v_fmac_f32 v11, v127, v115
  v_fmac_f32 v12, v127, v116
  v_fmac_f32 v13, v127, v117
  v_fmac_f32 v14, v127, v118
  v_fmac_f32 v15, v127, v119
  v_mov_b32 v112, v8
  v_mov_b32 v113, v9
  v_mov_b32 v114, v10
  v_mov_b32 v115, v11
  v_mov_b32 v116, v12
  v_mov_b32 v117, v13
  v_mov_b32 v118, v14
  v_mov_b32 v119, v15
  v_permlane16_swap_b32 v8, v112
  v_permlane16_swap_b32 v9, v113
  v_permlane16_swap_b32 v10, v114
  v_permlane16_swap_b32 v11, v115
  v_permlane16_swap_b32 v12, v116
  v_permlane16_swap_b32 v13, v117
  v_permlane16_swap_b32 v14, v118
  v_permlane16_swap_b32 v15, v119
  v_add_f32 v8, v8, v112
  v_add_f32 v9, v9, v113
  v_add_f32 v10, v10, v114
  v_add_f32 v11, v11, v115
  v_add_f32 v12, v12, v116
  v_add_f32 v13, v13, v117
  v_add_f32 v14, v14, v118
  v_add_f32 v15, v15, v119
  v_mov_b32 v112, v8
  v_mov_b32 v113, v9
  v_mov_b32 v114, v10
  v_mov_b32 v115, v11
  v_mov_b32 v116, v12
  v_mov_b32 v117, v13
  v_mov_b32 v118, v14
  v_mov_b32 v119, v15
  v_permlane32_swap_b32 v8, v112
  v_permlane32_swap_b32 v9, v113
  v_permlane32_swap_b32 v10, v114
  v_permlane32_swap_b32 v11, v115
  v_permlane32_swap_b32 v12, v116
  v_permlane32_swap_b32 v13, v117
  v_permlane32_swap_b32 v14, v118
  v_permlane32_swap_b32 v15, v119
  v_add_f32 v8, v8, v112
  v_add_f32 v9, v9, v113
  v_add_f32 v10, v10, v114
  v_add_f32 v11, v11, v115
  v_add_f32 v12, v12, v116
  v_add_f32 v13, v13, v117
  v_add_f32 v14, v14, v118
  v_add_f32 v15, v15, v119
  s_lshl_b32 s16, s3, 9
  s_add_u32 s16, s16, 98304
  v_and_b32 v112, 15, v1
  v_lshlrev_b32 v112, 5, v112
  v_add_u32 v112, s16, v112
  ds_write_b128 v112, v[8:11]
  ds_write_b128 v112, v[12:15] offset:16
  s_waitcnt lgkmcnt(0)
  s_barrier
  v_and_b32 v112, 15, v1
  v_lshlrev_b32 v112, 5, v112
  v_add_u32 v112, 98304, v112
  ds_read_b128 v[8:11], v112
  ds_read_b128 v[12:15], v112 offset:16
  ds_read_b128 v[16:19], v112 offset:512
  ds_read_b128 v[20:23], v112 offset:528
  ds_read_b128 v[24:27], v112 offset:1024
  ds_read_b128 v[28:31], v112 offset:1040
  ds_read_b128 v[32:35], v112 offset:1536
  ds_read_b128 v[36:39], v112 offset:1552
  ds_read_b128 v[40:43], v112 offset:2048
  ds_read_b128 v[44:47], v112 offset:2064
  s_waitcnt lgkmcnt(0)
  v_add_f32 v8, v8, v16
  v_add_f32 v9, v9, v17
  v_add_f32 v10, v10, v18
  v_add_f32 v11, v11, v19
  v_add_f32 v12, v12, v20
  v_add_f32 v13, v13, v21
  v_add_f32 v14, v14, v22
  v_add_f32 v15, v15, v23
  v_add_f32 v8, v8, v24
  v_add_f32 v9, v9, v25
  v_add_f32 v10, v10, v26
  v_add_f32 v11, v11, v27
  v_add_f32 v12, v12, v28
  v_add_f32 v13, v13, v29
  v_add_f32 v14, v14, v30
  v_add_f32 v15, v15, v31
  v_add_f32 v8, v8, v32
  v_add_f32 v9, v9, v33
  v_add_f32 v10, v10, v34
  v_add_f32 v11, v11, v35
  v_add_f32 v12, v12, v36
  v_add_f32 v13, v13, v37
  v_add_f32 v14, v14, v38
  v_add_f32 v15, v15, v39
  v_add_f32 v8, v8, v40
  v_add_f32 v9, v9, v41
  v_add_f32 v10, v10, v42
  v_add_f32 v11, v11, v43
  v_add_f32 v12, v12, v44
  v_add_f32 v13, v13, v45
  v_add_f32 v14, v14, v46
  v_add_f32 v15, v15, v47
  ds_read_b128 v[16:19], v112 offset:2560
  ds_read_b128 v[20:23], v112 offset:2576
  ds_read_b128 v[24:27], v112 offset:3072
  ds_read_b128 v[28:31], v112 offset:3088
  ds_read_b128 v[32:35], v112 offset:3584
  ds_read_b128 v[36:39], v112 offset:3600
  ds_read_b128 v[40:43], v112 offset:4096
  ds_read_b128 v[44:47], v112 offset:4112
  s_waitcnt lgkmcnt(0)
  v_add_f32 v8, v8, v16
  v_add_f32 v9, v9, v17
  v_add_f32 v10, v10, v18
  v_add_f32 v11, v11, v19
  v_add_f32 v12, v12, v20
  v_add_f32 v13, v13, v21
  v_add_f32 v14, v14, v22
  v_add_f32 v15, v15, v23
  v_add_f32 v8, v8, v24
  v_add_f32 v9, v9, v25
  v_add_f32 v10, v10, v26
  v_add_f32 v11, v11, v27
  v_add_f32 v12, v12, v28
  v_add_f32 v13, v13, v29
  v_add_f32 v14, v14, v30
  v_add_f32 v15, v15, v31
  v_add_f32 v8, v8, v32
  v_add_f32 v9, v9, v33
  v_add_f32 v10, v10, v34
  v_add_f32 v11, v11, v35
  v_add_f32 v12, v12, v36
  v_add_f32 v13, v13, v37
  v_add_f32 v14, v14, v38
  v_add_f32 v15, v15, v39
  v_add_f32 v8, v8, v40
  v_add_f32 v9, v9, v41
  v_add_f32 v10, v10, v42
  v_add_f32 v11, v11, v43
  v_add_f32 v12, v12, v44
  v_add_f32 v13, v13, v45
  v_add_f32 v14, v14, v46
  v_add_f32 v15, v15, v47
  ds_read_b128 v[16:19], v112 offset:4608
  ds_read_b128 v[20:23], v112 offset:4624
  ds_read_b128 v[24:27], v112 offset:5120
  ds_read_b128 v[28:31], v112 offset:5136
  ds_read_b128 v[32:35], v112 offset:5632
  ds_read_b128 v[36:39], v112 offset:5648
  ds_read_b128 v[40:43], v112 offset:6144
  ds_read_b128 v[44:47], v112 offset:6160
  s_waitcnt lgkmcnt(0)
  v_add_f32 v8, v8, v16
  v_add_f32 v9, v9, v17
  v_add_f32 v10, v10, v18
  v_add_f32 v11, v11, v19
  v_add_f32 v12, v12, v20
  v_add_f32 v13, v13, v21
  v_add_f32 v14, v14, v22
  v_add_f32 v15, v15, v23
  v_add_f32 v8, v8, v24
  v_add_f32 v9, v9, v25
  v_add_f32 v10, v10, v26
  v_add_f32 v11, v11, v27
  v_add_f32 v12, v12, v28
  v_add_f32 v13, v13, v29
  v_add_f32 v14, v14, v30
  v_add_f32 v15, v15, v31
  v_add_f32 v8, v8, v32
  v_add_f32 v9, v9, v33
  v_add_f32 v10, v10, v34
  v_add_f32 v11, v11, v35
  v_add_f32 v12, v12, v36
  v_add_f32 v13, v13, v37
  v_add_f32 v14, v14, v38
  v_add_f32 v15, v15, v39
  v_add_f32 v8, v8, v40
  v_add_f32 v9, v9, v41
  v_add_f32 v10, v10, v42
  v_add_f32 v11, v11, v43
  v_add_f32 v12, v12, v44
  v_add_f32 v13, v13, v45
  v_add_f32 v14, v14, v46
  v_add_f32 v15, v15, v47
  ds_read_b128 v[16:19], v112 offset:6656
  ds_read_b128 v[20:23], v112 offset:6672
  ds_read_b128 v[24:27], v112 offset:7168
  ds_read_b128 v[28:31], v112 offset:7184
  ds_read_b128 v[32:35], v112 offset:7680
  ds_read_b128 v[36:39], v112 offset:7696
  s_waitcnt lgkmcnt(0)
  v_add_f32 v8, v8, v16
  v_add_f32 v9, v9, v17
  v_add_f32 v10, v10, v18
  v_add_f32 v11, v11, v19
  v_add_f32 v12, v12, v20
  v_add_f32 v13, v13, v21
  v_add_f32 v14, v14, v22
  v_add_f32 v15, v15, v23
  v_add_f32 v8, v8, v24
  v_add_f32 v9, v9, v25
  v_add_f32 v10, v10, v26
  v_add_f32 v11, v11, v27
  v_add_f32 v12, v12, v28
  v_add_f32 v13, v13, v29
  v_add_f32 v14, v14, v30
  v_add_f32 v15, v15, v31
  v_add_f32 v8, v8, v32
  v_add_f32 v9, v9, v33
  v_add_f32 v10, v10, v34
  v_add_f32 v11, v11, v35
  v_add_f32 v12, v12, v36
  v_add_f32 v13, v13, v37
  v_add_f32 v14, v14, v38
  v_add_f32 v15, v15, v39
  v_cvt_pk_bf16_f32 v4, v8, v9
  v_cvt_pk_bf16_f32 v5, v10, v11
  v_cvt_pk_bf16_f32 v6, v12, v13
  v_cvt_pk_bf16_f32 v7, v14, v15
  s_add_u32 s17, s99, 6144
  buffer_load_dwordx4 v[72:75], v2, s[48:51], s17 offen nt
  s_add_u32 s17, s99, 7168
  buffer_load_dwordx4 v[76:79], v2, s[48:51], s17 offen nt
  s_add_u32 s17, s99, 8192
  buffer_load_dwordx4 v[80:83], v2, s[48:51], s17 offen nt
  s_add_u32 s17, s99, 9216
  buffer_load_dwordx4 v[84:87], v2, s[48:51], s17 offen nt
  s_add_u32 s17, s99, 10240
  buffer_load_dwordx4 v[88:91], v2, s[48:51], s17 offen nt
  s_add_u32 s17, s99, 11264
  buffer_load_dwordx4 v[92:95], v2, s[48:51], s17 offen nt
  s_add_u32 s17, s99, 12288
  buffer_load_dwordx4 v[96:99], v2, s[48:51], s17 offen nt
  s_add_u32 s17, s99, 13312
  buffer_load_dwordx4 v[100:103], v2, s[48:51], s17 offen nt
  s_add_u32 s17, s99, 14336
  buffer_load_dwordx4 v[104:107], v2, s[48:51], s17 offen nt
  s_add_u32 s17, s99, 15360
  buffer_load_dwordx4 v[108:111], v2, s[48:51], s17 offen nt
  s_waitcnt vmcnt(12)
  v_dot2_f32_bf16 v112, v48, v4, 0
  v_dot2_f32_bf16 v113, v52, v4, 0
  v_dot2_f32_bf16 v114, v56, v4, 0
  v_dot2_f32_bf16 v115, v60, v4, 0
  v_dot2_f32_bf16 v112, v49, v5, v112
  v_dot2_f32_bf16 v113, v53, v5, v113
  v_dot2_f32_bf16 v114, v57, v5, v114
  v_dot2_f32_bf16 v115, v61, v5, v115
  v_dot2_f32_bf16 v112, v50, v6, v112
  v_dot2_f32_bf16 v113, v54, v6, v113
  v_dot2_f32_bf16 v114, v58, v6, v114
  v_dot2_f32_bf16 v115, v62, v6, v115
  v_dot2_f32_bf16 v112, v51, v7, v112
  v_dot2_f32_bf16 v113, v55, v7, v113
  v_dot2_f32_bf16 v114, v59, v7, v114
  v_dot2_f32_bf16 v115, v63, v7, v115
  s_add_u32 s17, s99, 16384
  buffer_load_dwordx4 v[48:51], v2, s[48:51], s17 offen nt
  s_add_u32 s17, s99, 17408
  buffer_load_dwordx4 v[52:55], v2, s[48:51], s17 offen nt
  s_add_u32 s17, s99, 18432
  buffer_load_dwordx4 v[56:59], v2, s[48:51], s17 offen nt
  s_add_u32 s17, s99, 19456
  buffer_load_dwordx4 v[60:63], v2, s[48:51], s17 offen nt
  v_add_f32_dpp v112, v112, v112 row_ror:8 row_mask:0xf bank_mask:0xf
  v_add_f32_dpp v113, v113, v113 row_ror:8 row_mask:0xf bank_mask:0xf
  v_add_f32_dpp v114, v114, v114 row_ror:8 row_mask:0xf bank_mask:0xf
  v_add_f32_dpp v115, v115, v115 row_ror:8 row_mask:0xf bank_mask:0xf
  v_add_f32_dpp v112, v112, v112 row_ror:4 row_mask:0xf bank_mask:0xf
  v_add_f32_dpp v113, v113, v113 row_ror:4 row_mask:0xf bank_mask:0xf
  v_add_f32_dpp v114, v114, v114 row_ror:4 row_mask:0xf bank_mask:0xf
  v_add_f32_dpp v115, v115, v115 row_ror:4 row_mask:0xf bank_mask:0xf
  v_add_f32_dpp v112, v112, v112 row_ror:2 row_mask:0xf bank_mask:0xf
  v_add_f32_dpp v113, v113, v113 row_ror:2 row_mask:0xf bank_mask:0xf
  v_add_f32_dpp v114, v114, v114 row_ror:2 row_mask:0xf bank_mask:0xf
  v_add_f32_dpp v115, v115, v115 row_ror:2 row_mask:0xf bank_mask:0xf
  v_add_f32_dpp v16, v112, v112 row_ror:1 row_mask:0xf bank_mask:0xf
  v_add_f32_dpp v17, v113, v113 row_ror:1 row_mask:0xf bank_mask:0xf
  v_add_f32_dpp v18, v114, v114 row_ror:1 row_mask:0xf bank_mask:0xf
  v_add_f32_dpp v19, v115, v115 row_ror:1 row_mask:0xf bank_mask:0xf
  s_waitcnt vmcnt(12)
  v_dot2_f32_bf16 v112, v64, v4, 0
  v_dot2_f32_bf16 v113, v68, v4, 0
  v_dot2_f32_bf16 v114, v72, v4, 0
  v_dot2_f32_bf16 v115, v76, v4, 0
  v_dot2_f32_bf16 v112, v65, v5, v112
  v_dot2_f32_bf16 v113, v69, v5, v113
  v_dot2_f32_bf16 v114, v73, v5, v114
  v_dot2_f32_bf16 v115, v77, v5, v115
  v_dot2_f32_bf16 v112, v66, v6, v112
  v_dot2_f32_bf16 v113, v70, v6, v113
  v_dot2_f32_bf16 v114, v74, v6, v114
  v_dot2_f32_bf16 v115, v78, v6, v115
  v_dot2_f32_bf16 v112, v67, v7, v112
  v_dot2_f32_bf16 v113, v71, v7, v113
  v_dot2_f32_bf16 v114, v75, v7, v114
  v_dot2_f32_bf16 v115, v79, v7, v115
  s_add_u32 s17, s99, 20480
  buffer_load_dwordx4 v[64:67], v2, s[48:51], s17 offen nt
  s_add_u32 s17, s99, 21504
  buffer_load_dwordx4 v[68:71], v2, s[48:51], s17 offen nt
  s_add_u32 s17, s99, 22528
  buffer_load_dwordx4 v[72:75], v2, s[48:51], s17 offen nt
  s_add_u32 s17, s99, 23552
  buffer_load_dwordx4 v[76:79], v2, s[48:51], s17 offen nt
  v_add_f32_dpp v112, v112, v112 row_ror:8 row_mask:0xf bank_mask:0xf
  v_add_f32_dpp v113, v113, v113 row_ror:8 row_mask:0xf bank_mask:0xf
  v_add_f32_dpp v114, v114, v114 row_ror:8 row_mask:0xf bank_mask:0xf
  v_add_f32_dpp v115, v115, v115 row_ror:8 row_mask:0xf bank_mask:0xf
  v_add_f32_dpp v112, v112, v112 row_ror:4 row_mask:0xf bank_mask:0xf
  v_add_f32_dpp v113, v113, v113 row_ror:4 row_mask:0xf bank_mask:0xf
  v_add_f32_dpp v114, v114, v114 row_ror:4 row_mask:0xf bank_mask:0xf
  v_add_f32_dpp v115, v115, v115 row_ror:4 row_mask:0xf bank_mask:0xf
  v_add_f32_dpp v112, v112, v112 row_ror:2 row_mask:0xf bank_mask:0xf
  v_add_f32_dpp v113, v113, v113 row_ror:2 row_mask:0xf bank_mask:0xf
  v_add_f32_dpp v114, v114, v114 row_ror:2 row_mask:0xf bank_mask:0xf
  v_add_f32_dpp v115, v115, v115 row_ror:2 row_mask:0xf bank_mask:0xf
  v_add_f32_dpp v20, v112, v112 row_ror:1 row_mask:0xf bank_mask:0xf
  v_add_f32_dpp v21, v113, v113 row_ror:1 row_mask:0xf bank_mask:0xf
  v_add_f32_dpp v22, v114, v114 row_ror:1 row_mask:0xf bank_mask:0xf
  v_add_f32_dpp v23, v115, v115 row_ror:1 row_mask:0xf bank_mask:0xf
  s_waitcnt vmcnt(12)
  v_dot2_f32_bf16 v112, v80, v4, 0
  v_dot2_f32_bf16 v113, v84, v4, 0
  v_dot2_f32_bf16 v114, v88, v4, 0
  v_dot2_f32_bf16 v115, v92, v4, 0
  v_dot2_f32_bf16 v112, v81, v5, v112
  v_dot2_f32_bf16 v113, v85, v5, v113
  v_dot2_f32_bf16 v114, v89, v5, v114
  v_dot2_f32_bf16 v115, v93, v5, v115
  v_dot2_f32_bf16 v112, v82, v6, v112
  v_dot2_f32_bf16 v113, v86, v6, v113
  v_dot2_f32_bf16 v114, v90, v6, v114
  v_dot2_f32_bf16 v115, v94, v6, v115
  v_dot2_f32_bf16 v112, v83, v7, v112
  v_dot2_f32_bf16 v113, v87, v7, v113
  v_dot2_f32_bf16 v114, v91, v7, v114
  v_dot2_f32_bf16 v115, v95, v7, v115
  s_add_u32 s17, s99, 24576
  buffer_load_dwordx4 v[80:83], v2, s[48:51], s17 offen nt
  s_add_u32 s17, s99, 25600
  buffer_load_dwordx4 v[84:87], v2, s[48:51], s17 offen nt
  s_add_u32 s17, s99, 26624
  buffer_load_dwordx4 v[88:91], v2, s[48:51], s17 offen nt
  s_add_u32 s17, s99, 27648
  buffer_load_dwordx4 v[92:95], v2, s[48:51], s17 offen nt
  v_add_f32_dpp v112, v112, v112 row_ror:8 row_mask:0xf bank_mask:0xf
  v_add_f32_dpp v113, v113, v113 row_ror:8 row_mask:0xf bank_mask:0xf
  v_add_f32_dpp v114, v114, v114 row_ror:8 row_mask:0xf bank_mask:0xf
  v_add_f32_dpp v115, v115, v115 row_ror:8 row_mask:0xf bank_mask:0xf
  v_add_f32_dpp v112, v112, v112 row_ror:4 row_mask:0xf bank_mask:0xf
  v_add_f32_dpp v113, v113, v113 row_ror:4 row_mask:0xf bank_mask:0xf
  v_add_f32_dpp v114, v114, v114 row_ror:4 row_mask:0xf bank_mask:0xf
  v_add_f32_dpp v115, v115, v115 row_ror:4 row_mask:0xf bank_mask:0xf
  v_add_f32_dpp v112, v112, v112 row_ror:2 row_mask:0xf bank_mask:0xf
  v_add_f32_dpp v113, v113, v113 row_ror:2 row_mask:0xf bank_mask:0xf
  v_add_f32_dpp v114, v114, v114 row_ror:2 row_mask:0xf bank_mask:0xf
  v_add_f32_dpp v115, v115, v115 row_ror:2 row_mask:0xf bank_mask:0xf
  v_add_f32_dpp v24, v112, v112 row_ror:1 row_mask:0xf bank_mask:0xf
  v_add_f32_dpp v25, v113, v113 row_ror:1 row_mask:0xf bank_mask:0xf
  v_add_f32_dpp v26, v114, v114 row_ror:1 row_mask:0xf bank_mask:0xf
  v_add_f32_dpp v27, v115, v115 row_ror:1 row_mask:0xf bank_mask:0xf
  s_waitcnt vmcnt(12)
  v_dot2_f32_bf16 v112, v96, v4, 0
  v_dot2_f32_bf16 v113, v100, v4, 0
  v_dot2_f32_bf16 v114, v104, v4, 0
  v_dot2_f32_bf16 v115, v108, v4, 0
  v_dot2_f32_bf16 v112, v97, v5, v112
  v_dot2_f32_bf16 v113, v101, v5, v113
  v_dot2_f32_bf16 v114, v105, v5, v114
  v_dot2_f32_bf16 v115, v109, v5, v115
  v_dot2_f32_bf16 v112, v98, v6, v112
  v_dot2_f32_bf16 v113, v102, v6, v113
  v_dot2_f32_bf16 v114, v106, v6, v114
  v_dot2_f32_bf16 v115, v110, v6, v115
  v_dot2_f32_bf16 v112, v99, v7, v112
  v_dot2_f32_bf16 v113, v103, v7, v113
  v_dot2_f32_bf16 v114, v107, v7, v114
  v_dot2_f32_bf16 v115, v111, v7, v115
  s_add_u32 s17, s99, 28672
  buffer_load_dwordx4 v[96:99], v2, s[48:51], s17 offen nt
  s_add_u32 s17, s99, 29696
  buffer_load_dwordx4 v[100:103], v2, s[48:51], s17 offen nt
  s_add_u32 s17, s99, 30720
  buffer_load_dwordx4 v[104:107], v2, s[48:51], s17 offen nt
  s_add_u32 s17, s99, 31744
  buffer_load_dwordx4 v[108:111], v2, s[48:51], s17 offen nt
  v_add_f32_dpp v112, v112, v112 row_ror:8 row_mask:0xf bank_mask:0xf
  v_add_f32_dpp v113, v113, v113 row_ror:8 row_mask:0xf bank_mask:0xf
  v_add_f32_dpp v114, v114, v114 row_ror:8 row_mask:0xf bank_mask:0xf
  v_add_f32_dpp v115, v115, v115 row_ror:8 row_mask:0xf bank_mask:0xf
  v_add_f32_dpp v112, v112, v112 row_ror:4 row_mask:0xf bank_mask:0xf
  v_add_f32_dpp v113, v113, v113 row_ror:4 row_mask:0xf bank_mask:0xf
  v_add_f32_dpp v114, v114, v114 row_ror:4 row_mask:0xf bank_mask:0xf
  v_add_f32_dpp v115, v115, v115 row_ror:4 row_mask:0xf bank_mask:0xf
  v_add_f32_dpp v112, v112, v112 row_ror:2 row_mask:0xf bank_mask:0xf
  v_add_f32_dpp v113, v113, v113 row_ror:2 row_mask:0xf bank_mask:0xf
  v_add_f32_dpp v114, v114, v114 row_ror:2 row_mask:0xf bank_mask:0xf
  v_add_f32_dpp v115, v115, v115 row_ror:2 row_mask:0xf bank_mask:0xf
  v_add_f32_dpp v28, v112, v112 row_ror:1 row_mask:0xf bank_mask:0xf
  v_add_f32_dpp v29, v113, v113 row_ror:1 row_mask:0xf bank_mask:0xf
  v_add_f32_dpp v30, v114, v114 row_ror:1 row_mask:0xf bank_mask:0xf
  v_add_f32_dpp v31, v115, v115 row_ror:1 row_mask:0xf bank_mask:0xf
  s_waitcnt vmcnt(12)
  v_dot2_f32_bf16 v112, v48, v4, 0
  v_dot2_f32_bf16 v113, v52, v4, 0
  v_dot2_f32_bf16 v114, v56, v4, 0
  v_dot2_f32_bf16 v115, v60, v4, 0
  v_dot2_f32_bf16 v112, v49, v5, v112
  v_dot2_f32_bf16 v113, v53, v5, v113
  v_dot2_f32_bf16 v114, v57, v5, v114
  v_dot2_f32_bf16 v115, v61, v5, v115
  v_dot2_f32_bf16 v112, v50, v6, v112
  v_dot2_f32_bf16 v113, v54, v6, v113
  v_dot2_f32_bf16 v114, v58, v6, v114
  v_dot2_f32_bf16 v115, v62, v6, v115
  v_dot2_f32_bf16 v112, v51, v7, v112
  v_dot2_f32_bf16 v113, v55, v7, v113
  v_dot2_f32_bf16 v114, v59, v7, v114
  v_dot2_f32_bf16 v115, v63, v7, v115
  s_add_u32 s17, s99, 0
  buffer_load_dwordx4 v[48:51], v2, s[52:55], s17 offen nt
  s_add_u32 s17, s99, 1024
  buffer_load_dwordx4 v[52:55], v2, s[52:55], s17 offen nt
  s_add_u32 s17, s99, 2048
  buffer_load_dwordx4 v[56:59], v2, s[52:55], s17 offen nt
  s_add_u32 s17, s99, 3072
  buffer_load_dwordx4 v[60:63], v2, s[52:55], s17 offen nt
  v_add_f32_dpp v112, v112, v112 row_ror:8 row_mask:0xf bank_mask:0xf
  v_add_f32_dpp v113, v113, v113 row_ror:8 row_mask:0xf bank_mask:0xf
  v_add_f32_dpp v114, v114, v114 row_ror:8 row_mask:0xf bank_mask:0xf
  v_add_f32_dpp v115, v115, v115 row_ror:8 row_mask:0xf bank_mask:0xf
  v_add_f32_dpp v112, v112, v112 row_ror:4 row_mask:0xf bank_mask:0xf
  v_add_f32_dpp v113, v113, v113 row_ror:4 row_mask:0xf bank_mask:0xf
  v_add_f32_dpp v114, v114, v114 row_ror:4 row_mask:0xf bank_mask:0xf
  v_add_f32_dpp v115, v115, v115 row_ror:4 row_mask:0xf bank_mask:0xf
  v_add_f32_dpp v112, v112, v112 row_ror:2 row_mask:0xf bank_mask:0xf
  v_add_f32_dpp v113, v113, v113 row_ror:2 row_mask:0xf bank_mask:0xf
  v_add_f32_dpp v114, v114, v114 row_ror:2 row_mask:0xf bank_mask:0xf
  v_add_f32_dpp v115, v115, v115 row_ror:2 row_mask:0xf bank_mask:0xf
  v_add_f32_dpp v32, v112, v112 row_ror:1 row_mask:0xf bank_mask:0xf
  v_add_f32_dpp v33, v113, v113 row_ror:1 row_mask:0xf bank_mask:0xf
  v_add_f32_dpp v34, v114, v114 row_ror:1 row_mask:0xf bank_mask:0xf
  v_add_f32_dpp v35, v115, v115 row_ror:1 row_mask:0xf bank_mask:0xf
  s_waitcnt vmcnt(12)
  v_dot2_f32_bf16 v112, v64, v4, 0
  v_dot2_f32_bf16 v113, v68, v4, 0
  v_dot2_f32_bf16 v114, v72, v4, 0
  v_dot2_f32_bf16 v115, v76, v4, 0
  v_dot2_f32_bf16 v112, v65, v5, v112
  v_dot2_f32_bf16 v113, v69, v5, v113
  v_dot2_f32_bf16 v114, v73, v5, v114
  v_dot2_f32_bf16 v115, v77, v5, v115
  v_dot2_f32_bf16 v112, v66, v6, v112
  v_dot2_f32_bf16 v113, v70, v6, v113
  v_dot2_f32_bf16 v114, v74, v6, v114
  v_dot2_f32_bf16 v115, v78, v6, v115
  v_dot2_f32_bf16 v112, v67, v7, v112
  v_dot2_f32_bf16 v113, v71, v7, v113
  v_dot2_f32_bf16 v114, v75, v7, v114
  v_dot2_f32_bf16 v115, v79, v7, v115
  s_add_u32 s17, s99, 4096
  buffer_load_dwordx4 v[64:67], v2, s[52:55], s17 offen nt
  s_add_u32 s17, s99, 5120
  buffer_load_dwordx4 v[68:71], v2, s[52:55], s17 offen nt
  s_add_u32 s17, s99, 6144
  buffer_load_dwordx4 v[72:75], v2, s[52:55], s17 offen nt
  s_add_u32 s17, s99, 7168
  buffer_load_dwordx4 v[76:79], v2, s[52:55], s17 offen nt
  v_add_f32_dpp v112, v112, v112 row_ror:8 row_mask:0xf bank_mask:0xf
  v_add_f32_dpp v113, v113, v113 row_ror:8 row_mask:0xf bank_mask:0xf
  v_add_f32_dpp v114, v114, v114 row_ror:8 row_mask:0xf bank_mask:0xf
  v_add_f32_dpp v115, v115, v115 row_ror:8 row_mask:0xf bank_mask:0xf
  v_add_f32_dpp v112, v112, v112 row_ror:4 row_mask:0xf bank_mask:0xf
  v_add_f32_dpp v113, v113, v113 row_ror:4 row_mask:0xf bank_mask:0xf
  v_add_f32_dpp v114, v114, v114 row_ror:4 row_mask:0xf bank_mask:0xf
  v_add_f32_dpp v115, v115, v115 row_ror:4 row_mask:0xf bank_mask:0xf
  v_add_f32_dpp v112, v112, v112 row_ror:2 row_mask:0xf bank_mask:0xf
  v_add_f32_dpp v113, v113, v113 row_ror:2 row_mask:0xf bank_mask:0xf
  v_add_f32_dpp v114, v114, v114 row_ror:2 row_mask:0xf bank_mask:0xf
  v_add_f32_dpp v115, v115, v115 row_ror:2 row_mask:0xf bank_mask:0xf
  v_add_f32_dpp v36, v112, v112 row_ror:1 row_mask:0xf bank_mask:0xf
  v_add_f32_dpp v37, v113, v113 row_ror:1 row_mask:0xf bank_mask:0xf
  v_add_f32_dpp v38, v114, v114 row_ror:1 row_mask:0xf bank_mask:0xf
  v_add_f32_dpp v39, v115, v115 row_ror:1 row_mask:0xf bank_mask:0xf
  s_waitcnt vmcnt(12)
  v_dot2_f32_bf16 v112, v80, v4, 0
  v_dot2_f32_bf16 v113, v84, v4, 0
  v_dot2_f32_bf16 v114, v88, v4, 0
  v_dot2_f32_bf16 v115, v92, v4, 0
  v_dot2_f32_bf16 v112, v81, v5, v112
  v_dot2_f32_bf16 v113, v85, v5, v113
  v_dot2_f32_bf16 v114, v89, v5, v114
  v_dot2_f32_bf16 v115, v93, v5, v115
  v_dot2_f32_bf16 v112, v82, v6, v112
  v_dot2_f32_bf16 v113, v86, v6, v113
  v_dot2_f32_bf16 v114, v90, v6, v114
  v_dot2_f32_bf16 v115, v94, v6, v115
  v_dot2_f32_bf16 v112, v83, v7, v112
  v_dot2_f32_bf16 v113, v87, v7, v113
  v_dot2_f32_bf16 v114, v91, v7, v114
  v_dot2_f32_bf16 v115, v95, v7, v115
  s_add_u32 s17, s99, 8192
  buffer_load_dwordx4 v[80:83], v2, s[52:55], s17 offen nt
  s_add_u32 s17, s99, 9216
  buffer_load_dwordx4 v[84:87], v2, s[52:55], s17 offen nt
  s_add_u32 s17, s99, 10240
  buffer_load_dwordx4 v[88:91], v2, s[52:55], s17 offen nt
  s_add_u32 s17, s99, 11264
  buffer_load_dwordx4 v[92:95], v2, s[52:55], s17 offen nt
  v_add_f32_dpp v112, v112, v112 row_ror:8 row_mask:0xf bank_mask:0xf
  v_add_f32_dpp v113, v113, v113 row_ror:8 row_mask:0xf bank_mask:0xf
  v_add_f32_dpp v114, v114, v114 row_ror:8 row_mask:0xf bank_mask:0xf
  v_add_f32_dpp v115, v115, v115 row_ror:8 row_mask:0xf bank_mask:0xf
  v_add_f32_dpp v112, v112, v112 row_ror:4 row_mask:0xf bank_mask:0xf
  v_add_f32_dpp v113, v113, v113 row_ror:4 row_mask:0xf bank_mask:0xf
  v_add_f32_dpp v114, v114, v114 row_ror:4 row_mask:0xf bank_mask:0xf
  v_add_f32_dpp v115, v115, v115 row_ror:4 row_mask:0xf bank_mask:0xf
  v_add_f32_dpp v112, v112, v112 row_ror:2 row_mask:0xf bank_mask:0xf
  v_add_f32_dpp v113, v113, v113 row_ror:2 row_mask:0xf bank_mask:0xf
  v_add_f32_dpp v114, v114, v114 row_ror:2 row_mask:0xf bank_mask:0xf
  v_add_f32_dpp v115, v115, v115 row_ror:2 row_mask:0xf bank_mask:0xf
  v_add_f32_dpp v40, v112, v112 row_ror:1 row_mask:0xf bank_mask:0xf
  v_add_f32_dpp v41, v113, v113 row_ror:1 row_mask:0xf bank_mask:0xf
  v_add_f32_dpp v42, v114, v114 row_ror:1 row_mask:0xf bank_mask:0xf
  v_add_f32_dpp v43, v115, v115 row_ror:1 row_mask:0xf bank_mask:0xf
  s_waitcnt vmcnt(12)
  v_dot2_f32_bf16 v112, v96, v4, 0
  v_dot2_f32_bf16 v113, v100, v4, 0
  v_dot2_f32_bf16 v114, v104, v4, 0
  v_dot2_f32_bf16 v115, v108, v4, 0
  v_dot2_f32_bf16 v112, v97, v5, v112
  v_dot2_f32_bf16 v113, v101, v5, v113
  v_dot2_f32_bf16 v114, v105, v5, v114
  v_dot2_f32_bf16 v115, v109, v5, v115
  v_dot2_f32_bf16 v112, v98, v6, v112
  v_dot2_f32_bf16 v113, v102, v6, v113
  v_dot2_f32_bf16 v114, v106, v6, v114
  v_dot2_f32_bf16 v115, v110, v6, v115
  v_dot2_f32_bf16 v112, v99, v7, v112
  v_dot2_f32_bf16 v113, v103, v7, v113
  v_dot2_f32_bf16 v114, v107, v7, v114
  v_dot2_f32_bf16 v115, v111, v7, v115
  s_add_u32 s17, s99, 12288
  buffer_load_dwordx4 v[96:99], v2, s[52:55], s17 offen nt
  s_add_u32 s17, s99, 13312
  buffer_load_dwordx4 v[100:103], v2, s[52:55], s17 offen nt
  s_add_u32 s17, s99, 14336
  buffer_load_dwordx4 v[104:107], v2, s[52:55], s17 offen nt
  s_add_u32 s17, s99, 15360
  buffer_load_dwordx4 v[108:111], v2, s[52:55], s17 offen nt
  v_add_f32_dpp v112, v112, v112 row_ror:8 row_mask:0xf bank_mask:0xf
  v_add_f32_dpp v113, v113, v113 row_ror:8 row_mask:0xf bank_mask:0xf
  v_add_f32_dpp v114, v114, v114 row_ror:8 row_mask:0xf bank_mask:0xf
  v_add_f32_dpp v115, v115, v115 row_ror:8 row_mask:0xf bank_mask:0xf
  v_add_f32_dpp v112, v112, v112 row_ror:4 row_mask:0xf bank_mask:0xf
  v_add_f32_dpp v113, v113, v113 row_ror:4 row_mask:0xf bank_mask:0xf
  v_add_f32_dpp v114, v114, v114 row_ror:4 row_mask:0xf bank_mask:0xf
  v_add_f32_dpp v115, v115, v115 row_ror:4 row_mask:0xf bank_mask:0xf
  v_add_f32_dpp v112, v112, v112 row_ror:2 row_mask:0xf bank_mask:0xf
  v_add_f32_dpp v113, v113, v113 row_ror:2 row_mask:0xf bank_mask:0xf
  v_add_f32_dpp v114, v114, v114 row_ror:2 row_mask:0xf bank_mask:0xf
  v_add_f32_dpp v115, v115, v115 row_ror:2 row_mask:0xf bank_mask:0xf
  v_add_f32_dpp v44, v112, v112 row_ror:1 row_mask:0xf bank_mask:0xf
  v_add_f32_dpp v45, v113, v113 row_ror:1 row_mask:0xf bank_mask:0xf
  v_add_f32_dpp v46, v114, v114 row_ror:1 row_mask:0xf bank_mask:0xf
  v_add_f32_dpp v47, v115, v115 row_ror:1 row_mask:0xf bank_mask:0xf
  s_mov_b32 s16, 0x3db504f3
  v_cvt_pk_bf16_f32 v16, v16, v16
  v_cvt_pk_bf16_f32 v17, v17, v17
  v_cvt_pk_bf16_f32 v18, v18, v18
  v_cvt_pk_bf16_f32 v19, v19, v19
  v_cvt_pk_bf16_f32 v20, v20, v20
  v_cvt_pk_bf16_f32 v21, v21, v21
  v_cvt_pk_bf16_f32 v22, v22, v22
  v_cvt_pk_bf16_f32 v23, v23, v23
  v_cvt_pk_bf16_f32 v24, v24, v24
  v_cvt_pk_bf16_f32 v25, v25, v25
  v_cvt_pk_bf16_f32 v26, v26, v26
  v_cvt_pk_bf16_f32 v27, v27, v27
  v_cvt_pk_bf16_f32 v28, v28, v28
  v_cvt_pk_bf16_f32 v29, v29, v29
  v_cvt_pk_bf16_f32 v30, v30, v30
  v_cvt_pk_bf16_f32 v31, v31, v31
  v_cvt_pk_bf16_f32 v32, v32, v32
  v_cvt_pk_bf16_f32 v33, v33, v33
  v_cvt_pk_bf16_f32 v34, v34, v34
  v_cvt_pk_bf16_f32 v35, v35, v35
  v_cvt_pk_bf16_f32 v36, v36, v36
  v_cvt_pk_bf16_f32 v37, v37, v37
  v_cvt_pk_bf16_f32 v38, v38, v38
  v_cvt_pk_bf16_f32 v39, v39, v39
  v_cvt_pk_bf16_f32 v40, v40, v40
  v_cvt_pk_bf16_f32 v41, v41, v41
  v_cvt_pk_bf16_f32 v42, v42, v42
  v_cvt_pk_bf16_f32 v43, v43, v43
  v_cvt_pk_bf16_f32 v44, v44, v44
  v_cvt_pk_bf16_f32 v45, v45, v45
  v_cvt_pk_bf16_f32 v46, v46, v46
  v_cvt_pk_bf16_f32 v47, v47, v47
  v_and_b32 v16, 0xffff0000, v16
  v_and_b32 v17, 0xffff0000, v17
  v_and_b32 v18, 0xffff0000, v18
  v_and_b32 v19, 0xffff0000, v19
  v_and_b32 v20, 0xffff0000, v20
  v_and_b32 v21, 0xffff0000, v21
  v_and_b32 v22, 0xffff0000, v22
  v_and_b32 v23, 0xffff0000, v23
  v_and_b32 v24, 0xffff0000, v24
  v_and_b32 v25, 0xffff0000, v25
  v_and_b32 v26, 0xffff0000, v26
  v_and_b32 v27, 0xffff0000, v27
  v_and_b32 v28, 0xffff0000, v28
  v_and_b32 v29, 0xffff0000, v29
  v_and_b32 v30, 0xffff0000, v30
  v_and_b32 v31, 0xffff0000, v31
  v_and_b32 v32, 0xffff0000, v32
  v_and_b32 v33, 0xffff0000, v33
  v_and_b32 v34, 0xffff0000, v34
  v_and_b32 v35, 0xffff0000, v35
  v_and_b32 v36, 0xffff0000, v36
  v_and_b32 v37, 0xffff0000, v37
  v_and_b32 v38, 0xffff0000, v38
  v_and_b32 v39, 0xffff0000, v39
  v_and_b32 v40, 0xffff0000, v40
  v_and_b32 v41, 0xffff0000, v41
  v_and_b32 v42, 0xffff0000, v42
  v_and_b32 v43, 0xffff0000, v43
  v_and_b32 v44, 0xffff0000, v44
  v_and_b32 v45, 0xffff0000, v45
  v_and_b32 v46, 0xffff0000, v46
  v_and_b32 v47, 0xffff0000, v47
  v_mul_f32 v16, s16, v16
  v_mul_f32 v17, s16, v17
  v_mul_f32 v18, s16, v18
  v_mul_f32 v19, s16, v19
  v_mul_f32 v20, s16, v20
  v_mul_f32 v21, s16, v21
  v_mul_f32 v22, s16, v22
  v_mul_f32 v23, s16, v23
  v_mul_f32 v24, s16, v24
  v_mul_f32 v25, s16, v25
  v_mul_f32 v26, s16, v26
  v_mul_f32 v27, s16, v27
  v_mul_f32 v28, s16, v28
  v_mul_f32 v29, s16, v29
  v_mul_f32 v30, s16, v30
  v_mul_f32 v31, s16, v31
  v_mul_f32 v32, s16, v32
  v_mul_f32 v33, s16, v33
  v_mul_f32 v34, s16, v34
  v_mul_f32 v35, s16, v35
  v_mul_f32 v36, s16, v36
  v_mul_f32 v37, s16, v37
  v_mul_f32 v38, s16, v38
  v_mul_f32 v39, s16, v39
  v_mul_f32 v40, s16, v40
  v_mul_f32 v41, s16, v41
  v_mul_f32 v42, s16, v42
  v_mul_f32 v43, s16, v43
  v_mul_f32 v44, s16, v44
  v_mul_f32 v45, s16, v45
  v_mul_f32 v46, s16, v46
  v_mul_f32 v47, s16, v47
  v_cvt_pk_bf16_f32 v16, v16, v16
  v_cvt_pk_bf16_f32 v17, v17, v17
  v_cvt_pk_bf16_f32 v18, v18, v18
  v_cvt_pk_bf16_f32 v19, v19, v19
  v_cvt_pk_bf16_f32 v20, v20, v20
  v_cvt_pk_bf16_f32 v21, v21, v21
  v_cvt_pk_bf16_f32 v22, v22, v22
  v_cvt_pk_bf16_f32 v23, v23, v23
  v_cvt_pk_bf16_f32 v24, v24, v24
  v_cvt_pk_bf16_f32 v25, v25, v25
  v_cvt_pk_bf16_f32 v26, v26, v26
  v_cvt_pk_bf16_f32 v27, v27, v27
  v_cvt_pk_bf16_f32 v28, v28, v28
  v_cvt_pk_bf16_f32 v29, v29, v29
  v_cvt_pk_bf16_f32 v30, v30, v30
  v_cvt_pk_bf16_f32 v31, v31, v31
  v_cvt_pk_bf16_f32 v32, v32, v32
  v_cvt_pk_bf16_f32 v33, v33, v33
  v_cvt_pk_bf16_f32 v34, v34, v34
  v_cvt_pk_bf16_f32 v35, v35, v35
  v_cvt_pk_bf16_f32 v36, v36, v36
  v_cvt_pk_bf16_f32 v37, v37, v37
  v_cvt_pk_bf16_f32 v38, v38, v38
  v_cvt_pk_bf16_f32 v39, v39, v39
  v_cvt_pk_bf16_f32 v40, v40, v40
  v_cvt_pk_bf16_f32 v41, v41, v41
  v_cvt_pk_bf16_f32 v42, v42, v42
  v_cvt_pk_bf16_f32 v43, v43, v43
  v_cvt_pk_bf16_f32 v44, v44, v44
  v_cvt_pk_bf16_f32 v45, v45, v45
  v_cvt_pk_bf16_f32 v46, v46, v46
  v_cvt_pk_bf16_f32 v47, v47, v47
  v_and_b32 v16, 0xffff0000, v16
  v_and_b32 v17, 0xffff0000, v17
  v_and_b32 v18, 0xffff0000, v18
  v_and_b32 v19, 0xffff0000, v19
  v_and_b32 v20, 0xffff0000, v20
  v_and_b32 v21, 0xffff0000, v21
  v_and_b32 v22, 0xffff0000, v22
  v_and_b32 v23, 0xffff0000, v23
  v_and_b32 v24, 0xffff0000, v24
  v_and_b32 v25, 0xffff0000, v25
  v_and_b32 v26, 0xffff0000, v26
  v_and_b32 v27, 0xffff0000, v27
  v_and_b32 v28, 0xffff0000, v28
  v_and_b32 v29, 0xffff0000, v29
  v_and_b32 v30, 0xffff0000, v30
  v_and_b32 v31, 0xffff0000, v31
  v_and_b32 v32, 0xffff0000, v32
  v_and_b32 v33, 0xffff0000, v33
  v_and_b32 v34, 0xffff0000, v34
  v_and_b32 v35, 0xffff0000, v35
  v_and_b32 v36, 0xffff0000, v36
  v_and_b32 v37, 0xffff0000, v37
  v_and_b32 v38, 0xffff0000, v38
  v_and_b32 v39, 0xffff0000, v39
  v_and_b32 v40, 0xffff0000, v40
  v_and_b32 v41, 0xffff0000, v41
  v_and_b32 v42, 0xffff0000, v42
  v_and_b32 v43, 0xffff0000, v43
  v_and_b32 v44, 0xffff0000, v44
  v_and_b32 v45, 0xffff0000, v45
  v_and_b32 v46, 0xffff0000, v46
  v_and_b32 v47, 0xffff0000, v47
  v_max3_f32 v116, v16, v17, v18
  v_max3_f32 v116, v116, v19, v20
  v_max3_f32 v116, v116, v21, v22
  v_max3_f32 v116, v116, v23, v24
  v_max3_f32 v116, v116, v25, v26
  v_max3_f32 v116, v116, v27, v28
  v_max3_f32 v116, v116, v29, v30
  v_max3_f32 v116, v116, v31, v32
  v_max3_f32 v116, v116, v33, v34
  v_max3_f32 v116, v116, v35, v36
  v_max3_f32 v116, v116, v37, v38
  v_max3_f32 v116, v116, v39, v40
  v_max3_f32 v116, v116, v41, v42
  v_max3_f32 v116, v116, v43, v44
  v_max3_f32 v116, v116, v45, v46
  v_max_f32 v116, v116, v47
  v_mov_b32 v118, v116
  s_nop 1
  v_permlane16_swap_b32 v116, v118
  v_max_f32 v116, v116, v118
  v_mov_b32 v118, v116
  s_nop 1
  v_permlane32_swap_b32 v116, v118
  v_max_f32 v116, v116, v118
  s_mov_b32 s16, 0x3fb8aa3b
  v_sub_f32 v16, v16, v116
  v_sub_f32 v17, v17, v116
  v_sub_f32 v18, v18, v116
  v_sub_f32 v19, v19, v116
  v_sub_f32 v20, v20, v116
  v_sub_f32 v21, v21, v116
  v_sub_f32 v22, v22, v116
  v_sub_f32 v23, v23, v116
  v_sub_f32 v24, v24, v116
  v_sub_f32 v25, v25, v116
  v_sub_f32 v26, v26, v116
  v_sub_f32 v27, v27, v116
  v_sub_f32 v28, v28, v116
  v_sub_f32 v29, v29, v116
  v_sub_f32 v30, v30, v116
  v_sub_f32 v31, v31, v116
  v_sub_f32 v32, v32, v116
  v_sub_f32 v33, v33, v116
  v_sub_f32 v34, v34, v116
  v_sub_f32 v35, v35, v116
  v_sub_f32 v36, v36, v116
  v_sub_f32 v37, v37, v116
  v_sub_f32 v38, v38, v116
  v_sub_f32 v39, v39, v116
  v_sub_f32 v40, v40, v116
  v_sub_f32 v41, v41, v116
  v_sub_f32 v42, v42, v116
  v_sub_f32 v43, v43, v116
  v_sub_f32 v44, v44, v116
  v_sub_f32 v45, v45, v116
  v_sub_f32 v46, v46, v116
  v_sub_f32 v47, v47, v116
  v_mul_f32 v16, s16, v16
  v_mul_f32 v17, s16, v17
  v_mul_f32 v18, s16, v18
  v_mul_f32 v19, s16, v19
  v_mul_f32 v20, s16, v20
  v_mul_f32 v21, s16, v21
  v_mul_f32 v22, s16, v22
  v_mul_f32 v23, s16, v23
  v_mul_f32 v24, s16, v24
  v_mul_f32 v25, s16, v25
  v_mul_f32 v26, s16, v26
  v_mul_f32 v27, s16, v27
  v_mul_f32 v28, s16, v28
  v_mul_f32 v29, s16, v29
  v_mul_f32 v30, s16, v30
  v_mul_f32 v31, s16, v31
  v_mul_f32 v32, s16, v32
  v_mul_f32 v33, s16, v33
  v_mul_f32 v34, s16, v34
  v_mul_f32 v35, s16, v35
  v_mul_f32 v36, s16, v36
  v_mul_f32 v37, s16, v37
  v_mul_f32 v38, s16, v38
  v_mul_f32 v39, s16, v39
  v_mul_f32 v40, s16, v40
  v_mul_f32 v41, s16, v41
  v_mul_f32 v42, s16, v42
  v_mul_f32 v43, s16, v43
  v_mul_f32 v44, s16, v44
  v_mul_f32 v45, s16, v45
  v_mul_f32 v46, s16, v46
  v_mul_f32 v47, s16, v47
  v_exp_f32 v16, v16
  v_exp_f32 v17, v17
  v_exp_f32 v18, v18
  v_exp_f32 v19, v19
  v_exp_f32 v20, v20
  v_exp_f32 v21, v21
  v_exp_f32 v22, v22
  v_exp_f32 v23, v23
  v_exp_f32 v24, v24
  v_exp_f32 v25, v25
  v_exp_f32 v26, v26
  v_exp_f32 v27, v27
  v_exp_f32 v28, v28
  v_exp_f32 v29, v29
  v_exp_f32 v30, v30
  v_exp_f32 v31, v31
  v_exp_f32 v32, v32
  v_exp_f32 v33, v33
  v_exp_f32 v34, v34
  v_exp_f32 v35, v35
  v_exp_f32 v36, v36
  v_exp_f32 v37, v37
  v_exp_f32 v38, v38
  v_exp_f32 v39, v39
  v_exp_f32 v40, v40
  v_exp_f32 v41, v41
  v_exp_f32 v42, v42
  v_exp_f32 v43, v43
  v_exp_f32 v44, v44
  v_exp_f32 v45, v45
  v_exp_f32 v46, v46
  v_exp_f32 v47, v47
  v_add_f32 v117, v16, v17
  v_add_f32 v117, v117, v18
  v_add_f32 v117, v117, v19
  v_add_f32 v117, v117, v20
  v_add_f32 v117, v117, v21
  v_add_f32 v117, v117, v22
  v_add_f32 v117, v117, v23
  v_add_f32 v117, v117, v24
  v_add_f32 v117, v117, v25
  v_add_f32 v117, v117, v26
  v_add_f32 v117, v117, v27
  v_add_f32 v117, v117, v28
  v_add_f32 v117, v117, v29
  v_add_f32 v117, v117, v30
  v_add_f32 v117, v117, v31
  v_add_f32 v117, v117, v32
  v_add_f32 v117, v117, v33
  v_add_f32 v117, v117, v34
  v_add_f32 v117, v117, v35
  v_add_f32 v117, v117, v36
  v_add_f32 v117, v117, v37
  v_add_f32 v117, v117, v38
  v_add_f32 v117, v117, v39
  v_add_f32 v117, v117, v40
  v_add_f32 v117, v117, v41
  v_add_f32 v117, v117, v42
  v_add_f32 v117, v117, v43
  v_add_f32 v117, v117, v44
  v_add_f32 v117, v117, v45
  v_add_f32 v117, v117, v46
  v_add_f32 v117, v117, v47
  v_mov_b32 v118, v117
  s_nop 1
  v_permlane16_swap_b32 v117, v118
  v_add_f32 v117, v117, v118
  v_mov_b32 v118, v117
  s_nop 1
  v_permlane32_swap_b32 v117, v118
  v_add_f32 v117, v117, v118
  s_lshl_b32 s16, s3, 3
  s_add_u32 s16, s16, 147456
  v_mov_b32 v118, s16
  ds_write_b64 v118, v[116:117]
  v_mov_b32 v8, 0
  v_mov_b32 v9, 0
  v_mov_b32 v10, 0
  v_mov_b32 v11, 0
  v_mov_b32 v12, 0
  v_mov_b32 v13, 0
  v_mov_b32 v14, 0
  v_mov_b32 v15, 0
  s_waitcnt vmcnt(15)
  v_lshlrev_b32 v120, 16, v48
  v_and_b32 v121, 0xffff0000, v48
  v_lshlrev_b32 v122, 16, v49
  v_and_b32 v123, 0xffff0000, v49
  v_lshlrev_b32 v124, 16, v50
  v_and_b32 v125, 0xffff0000, v50
  v_lshlrev_b32 v126, 16, v51
  v_and_b32 v127, 0xffff0000, v51
  s_add_u32 s17, s99, 16384
  buffer_load_dwordx4 v[48:51], v2, s[52:55], s17 offen nt
  v_fmac_f32 v8, v16, v120
  v_fmac_f32 v9, v16, v121
  v_fmac_f32 v10, v16, v122
  v_fmac_f32 v11, v16, v123
  v_fmac_f32 v12, v16, v124
  v_fmac_f32 v13, v16, v125
  v_fmac_f32 v14, v16, v126
  v_fmac_f32 v15, v16, v127
  s_waitcnt vmcnt(15)
  v_lshlrev_b32 v120, 16, v52
  v_and_b32 v121, 0xffff0000, v52
  v_lshlrev_b32 v122, 16, v53
  v_and_b32 v123, 0xffff0000, v53
  v_lshlrev_b32 v124, 16, v54
  v_and_b32 v125, 0xffff0000, v54
  v_lshlrev_b32 v126, 16, v55
  v_and_b32 v127, 0xffff0000, v55
  s_add_u32 s17, s99, 17408
  buffer_load_dwordx4 v[52:55], v2, s[52:55], s17 offen nt
  v_fmac_f32 v8, v17, v120
  v_fmac_f32 v9, v17, v121
  v_fmac_f32 v10, v17, v122
  v_fmac_f32 v11, v17, v123
  v_fmac_f32 v12, v17, v124
  v_fmac_f32 v13, v17, v125
  v_fmac_f32 v14, v17, v126
  v_fmac_f32 v15, v17, v127
  s_waitcnt vmcnt(15)
  v_lshlrev_b32 v120, 16, v56
  v_and_b32 v121, 0xffff0000, v56
  v_lshlrev_b32 v122, 16, v57
  v_and_b32 v123, 0xffff0000, v57
  v_lshlrev_b32 v124, 16, v58
  v_and_b32 v125, 0xffff0000, v58
  v_lshlrev_b32 v126, 16, v59
  v_and_b32 v127, 0xffff0000, v59
  s_add_u32 s17, s99, 18432
  buffer_load_dwordx4 v[56:59], v2, s[52:55], s17 offen nt
  v_fmac_f32 v8, v18, v120
  v_fmac_f32 v9, v18, v121
  v_fmac_f32 v10, v18, v122
  v_fmac_f32 v11, v18, v123
  v_fmac_f32 v12, v18, v124
  v_fmac_f32 v13, v18, v125
  v_fmac_f32 v14, v18, v126
  v_fmac_f32 v15, v18, v127
  s_waitcnt vmcnt(15)
  v_lshlrev_b32 v120, 16, v60
  v_and_b32 v121, 0xffff0000, v60
  v_lshlrev_b32 v122, 16, v61
  v_and_b32 v123, 0xffff0000, v61
  v_lshlrev_b32 v124, 16, v62
  v_and_b32 v125, 0xffff0000, v62
  v_lshlrev_b32 v126, 16, v63
  v_and_b32 v127, 0xffff0000, v63
  s_add_u32 s17, s99, 19456
  buffer_load_dwordx4 v[60:63], v2, s[52:55], s17 offen nt
  v_fmac_f32 v8, v19, v120
  v_fmac_f32 v9, v19, v121
  v_fmac_f32 v10, v19, v122
  v_fmac_f32 v11, v19, v123
  v_fmac_f32 v12, v19, v124
  v_fmac_f32 v13, v19, v125
  v_fmac_f32 v14, v19, v126
  v_fmac_f32 v15, v19, v127
  s_waitcnt vmcnt(15)
  v_lshlrev_b32 v120, 16, v64
  v_and_b32 v121, 0xffff0000, v64
  v_lshlrev_b32 v122, 16, v65
  v_and_b32 v123, 0xffff0000, v65
  v_lshlrev_b32 v124, 16, v66
  v_and_b32 v125, 0xffff0000, v66
  v_lshlrev_b32 v126, 16, v67
  v_and_b32 v127, 0xffff0000, v67
  s_add_u32 s17, s99, 20480
  buffer_load_dwordx4 v[64:67], v2, s[52:55], s17 offen nt
  v_fmac_f32 v8, v20, v120
  v_fmac_f32 v9, v20, v121
  v_fmac_f32 v10, v20, v122
  v_fmac_f32 v11, v20, v123
  v_fmac_f32 v12, v20, v124
  v_fmac_f32 v13, v20, v125
  v_fmac_f32 v14, v20, v126
  v_fmac_f32 v15, v20, v127
  s_waitcnt vmcnt(15)
  v_lshlrev_b32 v120, 16, v68
  v_and_b32 v121, 0xffff0000, v68
  v_lshlrev_b32 v122, 16, v69
  v_and_b32 v123, 0xffff0000, v69
  v_lshlrev_b32 v124, 16, v70
  v_and_b32 v125, 0xffff0000, v70
  v_lshlrev_b32 v126, 16, v71
  v_and_b32 v127, 0xffff0000, v71
  s_add_u32 s17, s99, 21504
  buffer_load_dwordx4 v[68:71], v2, s[52:55], s17 offen nt
  v_fmac_f32 v8, v21, v120
  v_fmac_f32 v9, v21, v121
  v_fmac_f32 v10, v21, v122
  v_fmac_f32 v11, v21, v123
  v_fmac_f32 v12, v21, v124
  v_fmac_f32 v13, v21, v125
  v_fmac_f32 v14, v21, v126
  v_fmac_f32 v15, v21, v127
  s_waitcnt vmcnt(15)
  v_lshlrev_b32 v120, 16, v72
  v_and_b32 v121, 0xffff0000, v72
  v_lshlrev_b32 v122, 16, v73
  v_and_b32 v123, 0xffff0000, v73
  v_lshlrev_b32 v124, 16, v74
  v_and_b32 v125, 0xffff0000, v74
  v_lshlrev_b32 v126, 16, v75
  v_and_b32 v127, 0xffff0000, v75
  s_add_u32 s17, s99, 22528
  buffer_load_dwordx4 v[72:75], v2, s[52:55], s17 offen nt
  v_fmac_f32 v8, v22, v120
  v_fmac_f32 v9, v22, v121
  v_fmac_f32 v10, v22, v122
  v_fmac_f32 v11, v22, v123
  v_fmac_f32 v12, v22, v124
  v_fmac_f32 v13, v22, v125
  v_fmac_f32 v14, v22, v126
  v_fmac_f32 v15, v22, v127
  s_waitcnt vmcnt(15)
  v_lshlrev_b32 v120, 16, v76
  v_and_b32 v121, 0xffff0000, v76
  v_lshlrev_b32 v122, 16, v77
  v_and_b32 v123, 0xffff0000, v77
  v_lshlrev_b32 v124, 16, v78
  v_and_b32 v125, 0xffff0000, v78
  v_lshlrev_b32 v126, 16, v79
  v_and_b32 v127, 0xffff0000, v79
  s_add_u32 s17, s99, 23552
  buffer_load_dwordx4 v[76:79], v2, s[52:55], s17 offen nt
  v_fmac_f32 v8, v23, v120
  v_fmac_f32 v9, v23, v121
  v_fmac_f32 v10, v23, v122
  v_fmac_f32 v11, v23, v123
  v_fmac_f32 v12, v23, v124
  v_fmac_f32 v13, v23, v125
  v_fmac_f32 v14, v23, v126
  v_fmac_f32 v15, v23, v127
  s_waitcnt lgkmcnt(0)
  s_barrier
  v_mov_b32 v118, 147456
  ds_read_b128 v[120:123], v118 offset:0
  s_waitcnt lgkmcnt(0)
  v_max_f32 v112, v120, v122
  ds_read_b128 v[120:123], v118 offset:16
  s_waitcnt lgkmcnt(0)
  v_max3_f32 v112, v112, v120, v122
  ds_read_b128 v[120:123], v118 offset:32
  s_waitcnt lgkmcnt(0)
  v_max3_f32 v112, v112, v120, v122
  ds_read_b128 v[120:123], v118 offset:48
  s_waitcnt lgkmcnt(0)
  v_max3_f32 v112, v112, v120, v122
  ds_read_b128 v[120:123], v118 offset:64
  s_waitcnt lgkmcnt(0)
  v_max3_f32 v112, v112, v120, v122
  ds_read_b128 v[120:123], v118 offset:80
  s_waitcnt lgkmcnt(0)
  v_max3_f32 v112, v112, v120, v122
  ds_read_b128 v[120:123], v118 offset:96
  s_waitcnt lgkmcnt(0)
  v_max3_f32 v112, v112, v120, v122
  ds_read_b128 v[120:123], v118 offset:112
  s_waitcnt lgkmcnt(0)
  v_max3_f32 v112, v112, v120, v122
  s_mov_b32 s16, 0x3fb8aa3b
  v_mov_b32 v113, 0
  ds_read_b128 v[120:123], v118 offset:0
  s_waitcnt lgkmcnt(0)
  v_sub_f32 v124, v120, v112
  v_sub_f32 v125, v122, v112
  v_mul_f32 v124, s16, v124
  v_mul_f32 v125, s16, v125
  v_exp_f32 v124, v124
  v_exp_f32 v125, v125
  v_fmac_f32 v113, v121, v124
  v_fmac_f32 v113, v123, v125
  ds_read_b128 v[120:123], v118 offset:16
  s_waitcnt lgkmcnt(0)
  v_sub_f32 v124, v120, v112
  v_sub_f32 v125, v122, v112
  v_mul_f32 v124, s16, v124
  v_mul_f32 v125, s16, v125
  v_exp_f32 v124, v124
  v_exp_f32 v125, v125
  v_fmac_f32 v113, v121, v124
  v_fmac_f32 v113, v123, v125
  ds_read_b128 v[120:123], v118 offset:32
  s_waitcnt lgkmcnt(0)
  v_sub_f32 v124, v120, v112
  v_sub_f32 v125, v122, v112
  v_mul_f32 v124, s16, v124
  v_mul_f32 v125, s16, v125
  v_exp_f32 v124, v124
  v_exp_f32 v125, v125
  v_fmac_f32 v113, v121, v124
  v_fmac_f32 v113, v123, v125
  ds_read_b128 v[120:123], v118 offset:48
  s_waitcnt lgkmcnt(0)
  v_sub_f32 v124, v120, v112
  v_sub_f32 v125, v122, v112
  v_mul_f32 v124, s16, v124
  v_mul_f32 v125, s16, v125
  v_exp_f32 v124, v124
  v_exp_f32 v125, v125
  v_fmac_f32 v113, v121, v124
  v_fmac_f32 v113, v123, v125
  ds_read_b128 v[120:123], v118 offset:64
  s_waitcnt lgkmcnt(0)
  v_sub_f32 v124, v120, v112
  v_sub_f32 v125, v122, v112
  v_mul_f32 v124, s16, v124
  v_mul_f32 v125, s16, v125
  v_exp_f32 v124, v124
  v_exp_f32 v125, v125
  v_fmac_f32 v113, v121, v124
  v_fmac_f32 v113, v123, v125
  ds_read_b128 v[120:123], v118 offset:80
  s_waitcnt lgkmcnt(0)
  v_sub_f32 v124, v120, v112
  v_sub_f32 v125, v122, v112
  v_mul_f32 v124, s16, v124
  v_mul_f32 v125, s16, v125
  v_exp_f32 v124, v124
  v_exp_f32 v125, v125
  v_fmac_f32 v113, v121, v124
  v_fmac_f32 v113, v123, v125
  ds_read_b128 v[120:123], v118 offset:96
  s_waitcnt lgkmcnt(0)
  v_sub_f32 v124, v120, v112
  v_sub_f32 v125, v122, v112
  v_mul_f32 v124, s16, v124
  v_mul_f32 v125, s16, v125
  v_exp_f32 v124, v124
  v_exp_f32 v125, v125
  v_fmac_f32 v113, v121, v124
  v_fmac_f32 v113, v123, v125
  ds_read_b128 v[120:123], v118 offset:112
  s_waitcnt lgkmcnt(0)
  v_sub_f32 v124, v120, v112
  v_sub_f32 v125, v122, v112
  v_mul_f32 v124, s16, v124
  v_mul_f32 v125, s16, v125
  v_exp_f32 v124, v124
  v_exp_f32 v125, v125
  v_fmac_f32 v113, v121, v124
  v_fmac_f32 v113, v123, v125
  s_cmp_eq_u32 s3, 0
  s_cbranch_scc0 L_nopub_n
  s_lshl_b32 s16, s2, 3
  s_add_u32 s16, s16, 32768
  v_mov_b32 v118, 0
  s_mov_b64 exec, 1
  buffer_store_dwordx2 v[112:113], v118, s[92:95], s16 offen sc1
  s_mov_b64 exec, -1
L_nopub_n:
  s_nop 1
  s_waitcnt vmcnt(15)
  v_lshlrev_b32 v120, 16, v80
  v_and_b32 v121, 0xffff0000, v80
  v_lshlrev_b32 v122, 16, v81
  v_and_b32 v123, 0xffff0000, v81
  v_lshlrev_b32 v124, 16, v82
  v_and_b32 v125, 0xffff0000, v82
  v_lshlrev_b32 v126, 16, v83
  v_and_b32 v127, 0xffff0000, v83
  s_add_u32 s17, s99, 24576
  buffer_load_dwordx4 v[80:83], v2, s[52:55], s17 offen nt
  v_fmac_f32 v8, v24, v120
  v_fmac_f32 v9, v24, v121
  v_fmac_f32 v10, v24, v122
  v_fmac_f32 v11, v24, v123
  v_fmac_f32 v12, v24, v124
  v_fmac_f32 v13, v24, v125
  v_fmac_f32 v14, v24, v126
  v_fmac_f32 v15, v24, v127
  s_waitcnt vmcnt(15)
  v_lshlrev_b32 v120, 16, v84
  v_and_b32 v121, 0xffff0000, v84
  v_lshlrev_b32 v122, 16, v85
  v_and_b32 v123, 0xffff0000, v85
  v_lshlrev_b32 v124, 16, v86
  v_and_b32 v125, 0xffff0000, v86
  v_lshlrev_b32 v126, 16, v87
  v_and_b32 v127, 0xffff0000, v87
  s_add_u32 s17, s99, 25600
  buffer_load_dwordx4 v[84:87], v2, s[52:55], s17 offen nt
  v_fmac_f32 v8, v25, v120
  v_fmac_f32 v9, v25, v121
  v_fmac_f32 v10, v25, v122
  v_fmac_f32 v11, v25, v123
  v_fmac_f32 v12, v25, v124
  v_fmac_f32 v13, v25, v125
  v_fmac_f32 v14, v25, v126
  v_fmac_f32 v15, v25, v127
  s_waitcnt vmcnt(15)
  v_lshlrev_b32 v120, 16, v88
  v_and_b32 v121, 0xffff0000, v88
  v_lshlrev_b32 v122, 16, v89
  v_and_b32 v123, 0xffff0000, v89
  v_lshlrev_b32 v124, 16, v90
  v_and_b32 v125, 0xffff0000, v90
  v_lshlrev_b32 v126, 16, v91
  v_and_b32 v127, 0xffff0000, v91
  s_add_u32 s17, s99, 26624
  buffer_load_dwordx4 v[88:91], v2, s[52:55], s17 offen nt
  v_fmac_f32 v8, v26, v120
  v_fmac_f32 v9, v26, v121
  v_fmac_f32 v10, v26, v122
  v_fmac_f32 v11, v26, v123
  v_fmac_f32 v12, v26, v124
  v_fmac_f32 v13, v26, v125
  v_fmac_f32 v14, v26, v126
  v_fmac_f32 v15, v26, v127
  s_waitcnt vmcnt(15)
  v_lshlrev_b32 v120, 16, v92
  v_and_b32 v121, 0xffff0000, v92
  v_lshlrev_b32 v122, 16, v93
  v_and_b32 v123, 0xffff0000, v93
  v_lshlrev_b32 v124, 16, v94
  v_and_b32 v125, 0xffff0000, v94
  v_lshlrev_b32 v126, 16, v95
  v_and_b32 v127, 0xffff0000, v95
  s_add_u32 s17, s99, 27648
  buffer_load_dwordx4 v[92:95], v2, s[52:55], s17 offen nt
  v_fmac_f32 v8, v27, v120
  v_fmac_f32 v9, v27, v121
  v_fmac_f32 v10, v27, v122
  v_fmac_f32 v11, v27, v123
  v_fmac_f32 v12, v27, v124
  v_fmac_f32 v13, v27, v125
  v_fmac_f32 v14, v27, v126
  v_fmac_f32 v15, v27, v127
  s_waitcnt vmcnt(15)
  v_lshlrev_b32 v120, 16, v96
  v_and_b32 v121, 0xffff0000, v96
  v_lshlrev_b32 v122, 16, v97
  v_and_b32 v123, 0xffff0000, v97
  v_lshlrev_b32 v124, 16, v98
  v_and_b32 v125, 0xffff0000, v98
  v_lshlrev_b32 v126, 16, v99
  v_and_b32 v127, 0xffff0000, v99
  s_add_u32 s17, s99, 28672
  buffer_load_dwordx4 v[96:99], v2, s[52:55], s17 offen nt
  v_fmac_f32 v8, v28, v120
  v_fmac_f32 v9, v28, v121
  v_fmac_f32 v10, v28, v122
  v_fmac_f32 v11, v28, v123
  v_fmac_f32 v12, v28, v124
  v_fmac_f32 v13, v28, v125
  v_fmac_f32 v14, v28, v126
  v_fmac_f32 v15, v28, v127
  s_waitcnt vmcnt(15)
  v_lshlrev_b32 v120, 16, v100
  v_and_b32 v121, 0xffff0000, v100
  v_lshlrev_b32 v122, 16, v101
  v_and_b32 v123, 0xffff0000, v101
  v_lshlrev_b32 v124, 16, v102
  v_and_b32 v125, 0xffff0000, v102
  v_lshlrev_b32 v126, 16, v103
  v_and_b32 v127, 0xffff0000, v103
  s_add_u32 s17, s99, 29696
  buffer_load_dwordx4 v[100:103], v2, s[52:55], s17 offen nt
  v_fmac_f32 v8, v29, v120
  v_fmac_f32 v9, v29, v121
  v_fmac_f32 v10, v29, v122
  v_fmac_f32 v11, v29, v123
  v_fmac_f32 v12, v29, v124
  v_fmac_f32 v13, v29, v125
  v_fmac_f32 v14, v29, v126
  v_fmac_f32 v15, v29, v127
  s_waitcnt vmcnt(15)
  v_lshlrev_b32 v120, 16, v104
  v_and_b32 v121, 0xffff0000, v104
  v_lshlrev_b32 v122, 16, v105
  v_and_b32 v123, 0xffff0000, v105
  v_lshlrev_b32 v124, 16, v106
  v_and_b32 v125, 0xffff0000, v106
  v_lshlrev_b32 v126, 16, v107
  v_and_b32 v127, 0xffff0000, v107
  s_add_u32 s17, s99, 30720
  buffer_load_dwordx4 v[104:107], v2, s[52:55], s17 offen nt
  v_fmac_f32 v8, v30, v120
  v_fmac_f32 v9, v30, v121
  v_fmac_f32 v10, v30, v122
  v_fmac_f32 v11, v30, v123
  v_fmac_f32 v12, v30, v124
  v_fmac_f32 v13, v30, v125
  v_fmac_f32 v14, v30, v126
  v_fmac_f32 v15, v30, v127
  s_waitcnt vmcnt(15)
  v_lshlrev_b32 v120, 16, v108
  v_and_b32 v121, 0xffff0000, v108
  v_lshlrev_b32 v122, 16, v109
  v_and_b32 v123, 0xffff0000, v109
  v_lshlrev_b32 v124, 16, v110
  v_and_b32 v125, 0xffff0000, v110
  v_lshlrev_b32 v126, 16, v111
  v_and_b32 v127, 0xffff0000, v111
  s_add_u32 s17, s99, 31744
  buffer_load_dwordx4 v[108:111], v2, s[52:55], s17 offen nt
  v_fmac_f32 v8, v31, v120
  v_fmac_f32 v9, v31, v121
  v_fmac_f32 v10, v31, v122
  v_fmac_f32 v11, v31, v123
  v_fmac_f32 v12, v31, v124
  v_fmac_f32 v13, v31, v125
  v_fmac_f32 v14, v31, v126
  v_fmac_f32 v15, v31, v127
  s_waitcnt vmcnt(15)
  v_lshlrev_b32 v120, 16, v48
  v_and_b32 v121, 0xffff0000, v48
  v_lshlrev_b32 v122, 16, v49
  v_and_b32 v123, 0xffff0000, v49
  v_lshlrev_b32 v124, 16, v50
  v_and_b32 v125, 0xffff0000, v50
  v_lshlrev_b32 v126, 16, v51
  v_and_b32 v127, 0xffff0000, v51
  s_lshl_b32 s17, s97, 17
  s_lshl_b32 s18, s3, 13
  s_add_u32 s17, s17, s18
  s_add_u32 s17, s17, 0
  buffer_load_dwordx4 v[48:51], v2, s[60:63], s17 offen
  v_fmac_f32 v8, v32, v120
  v_fmac_f32 v9, v32, v121
  v_fmac_f32 v10, v32, v122
  v_fmac_f32 v11, v32, v123
  v_fmac_f32 v12, v32, v124
  v_fmac_f32 v13, v32, v125
  v_fmac_f32 v14, v32, v126
  v_fmac_f32 v15, v32, v127
  s_waitcnt vmcnt(15)
  v_lshlrev_b32 v120, 16, v52
  v_and_b32 v121, 0xffff0000, v52
  v_lshlrev_b32 v122, 16, v53
  v_and_b32 v123, 0xffff0000, v53
  v_lshlrev_b32 v124, 16, v54
  v_and_b32 v125, 0xffff0000, v54
  v_lshlrev_b32 v126, 16, v55
  v_and_b32 v127, 0xffff0000, v55
  s_lshl_b32 s17, s97, 17
  s_lshl_b32 s18, s3, 13
  s_add_u32 s17, s17, s18
  s_add_u32 s17, s17, 1024
  buffer_load_dwordx4 v[52:55], v2, s[60:63], s17 offen
  v_fmac_f32 v8, v33, v120
  v_fmac_f32 v9, v33, v121
  v_fmac_f32 v10, v33, v122
  v_fmac_f32 v11, v33, v123
  v_fmac_f32 v12, v33, v124
  v_fmac_f32 v13, v33, v125
  v_fmac_f32 v14, v33, v126
  v_fmac_f32 v15, v33, v127
  s_waitcnt vmcnt(15)
  v_lshlrev_b32 v120, 16, v56
  v_and_b32 v121, 0xffff0000, v56
  v_lshlrev_b32 v122, 16, v57
  v_and_b32 v123, 0xffff0000, v57
  v_lshlrev_b32 v124, 16, v58
  v_and_b32 v125, 0xffff0000, v58
  v_lshlrev_b32 v126, 16, v59
  v_and_b32 v127, 0xffff0000, v59
  s_lshl_b32 s17, s97, 17
  s_lshl_b32 s18, s3, 13
  s_add_u32 s17, s17, s18
  s_add_u32 s17, s17, 2048
  buffer_load_dwordx4 v[56:59], v2, s[60:63], s17 offen
  v_fmac_f32 v8, v34, v120
  v_fmac_f32 v9, v34, v121
  v_fmac_f32 v10, v34, v122
  v_fmac_f32 v11, v34, v123
  v_fmac_f32 v12, v34, v124
  v_fmac_f32 v13, v34, v125
  v_fmac_f32 v14, v34, v126
  v_fmac_f32 v15, v34, v127
  s_waitcnt vmcnt(15)
  v_lshlrev_b32 v120, 16, v60
  v_and_b32 v121, 0xffff0000, v60
  v_lshlrev_b32 v122, 16, v61
  v_and_b32 v123, 0xffff0000, v61
  v_lshlrev_b32 v124, 16, v62
  v_and_b32 v125, 0xffff0000, v62
  v_lshlrev_b32 v126, 16, v63
  v_and_b32 v127, 0xffff0000, v63
  s_lshl_b32 s17, s97, 17
  s_lshl_b32 s18, s3, 13
  s_add_u32 s17, s17, s18
  s_add_u32 s17, s17, 3072
  buffer_load_dwordx4 v[60:63], v2, s[60:63], s17 offen
  v_fmac_f32 v8, v35, v120
  v_fmac_f32 v9, v35, v121
  v_fmac_f32 v10, v35, v122
  v_fmac_f32 v11, v35, v123
  v_fmac_f32 v12, v35, v124
  v_fmac_f32 v13, v35, v125
  v_fmac_f32 v14, v35, v126
  v_fmac_f32 v15, v35, v127
  s_waitcnt vmcnt(15)
  v_lshlrev_b32 v120, 16, v64
  v_and_b32 v121, 0xffff0000, v64
  v_lshlrev_b32 v122, 16, v65
  v_and_b32 v123, 0xffff0000, v65
  v_lshlrev_b32 v124, 16, v66
  v_and_b32 v125, 0xffff0000, v66
  v_lshlrev_b32 v126, 16, v67
  v_and_b32 v127, 0xffff0000, v67
  s_lshl_b32 s17, s97, 17
  s_lshl_b32 s18, s3, 13
  s_add_u32 s17, s17, s18
  s_add_u32 s17, s17, 4096
  buffer_load_dwordx4 v[64:67], v2, s[60:63], s17 offen
  v_fmac_f32 v8, v36, v120
  v_fmac_f32 v9, v36, v121
  v_fmac_f32 v10, v36, v122
  v_fmac_f32 v11, v36, v123
  v_fmac_f32 v12, v36, v124
  v_fmac_f32 v13, v36, v125
  v_fmac_f32 v14, v36, v126
  v_fmac_f32 v15, v36, v127
  s_xor_b32 s16, s2, 8
  s_lshl_b32 s16, s16, 3
  s_add_u32 s16, s16, 32768
  v_mov_b32 v118, 0
  buffer_load_dwordx2 v[114:115], v118, s[92:95], s16 offen sc1
  s_waitcnt vmcnt(16)
  v_lshlrev_b32 v120, 16, v68
  v_and_b32 v121, 0xffff0000, v68
  v_lshlrev_b32 v122, 16, v69
  v_and_b32 v123, 0xffff0000, v69
  v_lshlrev_b32 v124, 16, v70
  v_and_b32 v125, 0xffff0000, v70
  v_lshlrev_b32 v126, 16, v71
  v_and_b32 v127, 0xffff0000, v71
  s_lshl_b32 s17, s97, 17
  s_lshl_b32 s18, s3, 13
  s_add_u32 s17, s17, s18
  s_add_u32 s17, s17, 5120
  buffer_load_dwordx4 v[68:71], v2, s[60:63], s17 offen
  v_fmac_f32 v8, v37, v120
  v_fmac_f32 v9, v37, v121
  v_fmac_f32 v10, v37, v122
  v_fmac_f32 v11, v37, v123
  v_fmac_f32 v12, v37, v124
  v_fmac_f32 v13, v37, v125
  v_fmac_f32 v14, v37, v126
  v_fmac_f32 v15, v37, v127
  s_waitcnt vmcnt(16)
  v_lshlrev_b32 v120, 16, v72
  v_and_b32 v121, 0xffff0000, v72
  v_lshlrev_b32 v122, 16, v73
  v_and_b32 v123, 0xffff0000, v73
  v_lshlrev_b32 v124, 16, v74
  v_and_b32 v125, 0xffff0000, v74
  v_lshlrev_b32 v126, 16, v75
  v_and_b32 v127, 0xffff0000, v75
  s_lshl_b32 s17, s97, 17
  s_lshl_b32 s18, s3, 13
  s_add_u32 s17, s17, s18
  s_add_u32 s17, s17, 6144
  buffer_load_dwordx4 v[72:75], v2, s[60:63], s17 offen
  v_fmac_f32 v8, v38, v120
  v_fmac_f32 v9, v38, v121
  v_fmac_f32 v10, v38, v122
  v_fmac_f32 v11, v38, v123
  v_fmac_f32 v12, v38, v124
  v_fmac_f32 v13, v38, v125
  v_fmac_f32 v14, v38, v126
  v_fmac_f32 v15, v38, v127
  s_waitcnt vmcnt(16)
  v_lshlrev_b32 v120, 16, v76
  v_and_b32 v121, 0xffff0000, v76
  v_lshlrev_b32 v122, 16, v77
  v_and_b32 v123, 0xffff0000, v77
  v_lshlrev_b32 v124, 16, v78
  v_and_b32 v125, 0xffff0000, v78
  v_lshlrev_b32 v126, 16, v79
  v_and_b32 v127, 0xffff0000, v79
  s_lshl_b32 s17, s97, 17
  s_lshl_b32 s18, s3, 13
  s_add_u32 s17, s17, s18
  s_add_u32 s17, s17, 7168
  buffer_load_dwordx4 v[76:79], v2, s[60:63], s17 offen
  v_fmac_f32 v8, v39, v120
  v_fmac_f32 v9, v39, v121
  v_fmac_f32 v10, v39, v122
  v_fmac_f32 v11, v39, v123
  v_fmac_f32 v12, v39, v124
  v_fmac_f32 v13, v39, v125
  v_fmac_f32 v14, v39, v126
  v_fmac_f32 v15, v39, v127
  s_waitcnt vmcnt(16)
  v_lshlrev_b32 v120, 16, v80
  v_and_b32 v121, 0xffff0000, v80
  v_lshlrev_b32 v122, 16, v81
  v_and_b32 v123, 0xffff0000, v81
  v_lshlrev_b32 v124, 16, v82
  v_and_b32 v125, 0xffff0000, v82
  v_lshlrev_b32 v126, 16, v83
  v_and_b32 v127, 0xffff0000, v83
  v_fmac_f32 v8, v40, v120
  v_fmac_f32 v9, v40, v121
  v_fmac_f32 v10, v40, v122
  v_fmac_f32 v11, v40, v123
  v_fmac_f32 v12, v40, v124
  v_fmac_f32 v13, v40, v125
  v_fmac_f32 v14, v40, v126
  v_fmac_f32 v15, v40, v127
  s_waitcnt vmcnt(15)
  v_lshlrev_b32 v120, 16, v84
  v_and_b32 v121, 0xffff0000, v84
  v_lshlrev_b32 v122, 16, v85
  v_and_b32 v123, 0xffff0000, v85
  v_lshlrev_b32 v124, 16, v86
  v_and_b32 v125, 0xffff0000, v86
  v_lshlrev_b32 v126, 16, v87
  v_and_b32 v127, 0xffff0000, v87
  v_fmac_f32 v8, v41, v120
  v_fmac_f32 v9, v41, v121
  v_fmac_f32 v10, v41, v122
  v_fmac_f32 v11, v41, v123
  v_fmac_f32 v12, v41, v124
  v_fmac_f32 v13, v41, v125
  v_fmac_f32 v14, v41, v126
  v_fmac_f32 v15, v41, v127
  s_waitcnt vmcnt(14)
  v_lshlrev_b32 v120, 16, v88
  v_and_b32 v121, 0xffff0000, v88
  v_lshlrev_b32 v122, 16, v89
  v_and_b32 v123, 0xffff0000, v89
  v_lshlrev_b32 v124, 16, v90
  v_and_b32 v125, 0xffff0000, v90
  v_lshlrev_b32 v126, 16, v91
  v_and_b32 v127, 0xffff0000, v91
  v_fmac_f32 v8, v42, v120
  v_fmac_f32 v9, v42, v121
  v_fmac_f32 v10, v42, v122
  v_fmac_f32 v11, v42, v123
  v_fmac_f32 v12, v42, v124
  v_fmac_f32 v13, v42, v125
  v_fmac_f32 v14, v42, v126
  v_fmac_f32 v15, v42, v127
  s_waitcnt vmcnt(13)
  v_lshlrev_b32 v120, 16, v92
  v_and_b32 v121, 0xffff0000, v92
  v_lshlrev_b32 v122, 16, v93
  v_and_b32 v123, 0xffff0000, v93
  v_lshlrev_b32 v124, 16, v94
  v_and_b32 v125, 0xffff0000, v94
  v_lshlrev_b32 v126, 16, v95
  v_and_b32 v127, 0xffff0000, v95
  v_fmac_f32 v8, v43, v120
  v_fmac_f32 v9, v43, v121
  v_fmac_f32 v10, v43, v122
  v_fmac_f32 v11, v43, v123
  v_fmac_f32 v12, v43, v124
  v_fmac_f32 v13, v43, v125
  v_fmac_f32 v14, v43, v126
  v_fmac_f32 v15, v43, v127
  s_waitcnt vmcnt(12)
  v_lshlrev_b32 v120, 16, v96
  v_and_b32 v121, 0xffff0000, v96
  v_lshlrev_b32 v122, 16, v97
  v_and_b32 v123, 0xffff0000, v97
  v_lshlrev_b32 v124, 16, v98
  v_and_b32 v125, 0xffff0000, v98
  v_lshlrev_b32 v126, 16, v99
  v_and_b32 v127, 0xffff0000, v99
  v_fmac_f32 v8, v44, v120
  v_fmac_f32 v9, v44, v121
  v_fmac_f32 v10, v44, v122
  v_fmac_f32 v11, v44, v123
  v_fmac_f32 v12, v44, v124
  v_fmac_f32 v13, v44, v125
  v_fmac_f32 v14, v44, v126
  v_fmac_f32 v15, v44, v127
  s_waitcnt vmcnt(11)
  v_lshlrev_b32 v120, 16, v100
  v_and_b32 v121, 0xffff0000, v100
  v_lshlrev_b32 v122, 16, v101
  v_and_b32 v123, 0xffff0000, v101
  v_lshlrev_b32 v124, 16, v102
  v_and_b32 v125, 0xffff0000, v102
  v_lshlrev_b32 v126, 16, v103
  v_and_b32 v127, 0xffff0000, v103
  v_fmac_f32 v8, v45, v120
  v_fmac_f32 v9, v45, v121
  v_fmac_f32 v10, v45, v122
  v_fmac_f32 v11, v45, v123
  v_fmac_f32 v12, v45, v124
  v_fmac_f32 v13, v45, v125
  v_fmac_f32 v14, v45, v126
  v_fmac_f32 v15, v45, v127
  s_waitcnt vmcnt(10)
  v_lshlrev_b32 v120, 16, v104
  v_and_b32 v121, 0xffff0000, v104
  v_lshlrev_b32 v122, 16, v105
  v_and_b32 v123, 0xffff0000, v105
  v_lshlrev_b32 v124, 16, v106
  v_and_b32 v125, 0xffff0000, v106
  v_lshlrev_b32 v126, 16, v107
  v_and_b32 v127, 0xffff0000, v107
  v_fmac_f32 v8, v46, v120
  v_fmac_f32 v9, v46, v121
  v_fmac_f32 v10, v46, v122
  v_fmac_f32 v11, v46, v123
  v_fmac_f32 v12, v46, v124
  v_fmac_f32 v13, v46, v125
  v_fmac_f32 v14, v46, v126
  v_fmac_f32 v15, v46, v127
  s_waitcnt vmcnt(9)
  v_lshlrev_b32 v120, 16, v108
  v_and_b32 v121, 0xffff0000, v108
  v_lshlrev_b32 v122, 16, v109
  v_and_b32 v123, 0xffff0000, v109
  v_lshlrev_b32 v124, 16, v110
  v_and_b32 v125, 0xffff0000, v110
  v_lshlrev_b32 v126, 16, v111
  v_and_b32 v127, 0xffff0000, v111
  v_fmac_f32 v8, v47, v120
  v_fmac_f32 v9, v47, v121
  v_fmac_f32 v10, v47, v122
  v_fmac_f32 v11, v47, v123
  v_fmac_f32 v12, v47, v124
  v_fmac_f32 v13, v47, v125
  v_fmac_f32 v14, v47, v126
  v_fmac_f32 v15, v47, v127
  v_mov_b32 v120, v8
  v_mov_b32 v121, v9
  v_mov_b32 v122, v10
  v_mov_b32 v123, v11
  v_mov_b32 v124, v12
  v_mov_b32 v125, v13
  v_mov_b32 v126, v14
  v_mov_b32 v127, v15
  v_permlane16_swap_b32 v8, v120
  v_permlane16_swap_b32 v9, v121
  v_permlane16_swap_b32 v10, v122
  v_permlane16_swap_b32 v11, v123
  v_permlane16_swap_b32 v12, v124
  v_permlane16_swap_b32 v13, v125
  v_permlane16_swap_b32 v14, v126
  v_permlane16_swap_b32 v15, v127
  v_add_f32 v8, v8, v120
  v_add_f32 v9, v9, v121
  v_add_f32 v10, v10, v122
  v_add_f32 v11, v11, v123
  v_add_f32 v12, v12, v124
  v_add_f32 v13, v13, v125
  v_add_f32 v14, v14, v126
  v_add_f32 v15, v15, v127
  v_mov_b32 v120, v8
  v_mov_b32 v121, v9
  v_mov_b32 v122, v10
  v_mov_b32 v123, v11
  v_mov_b32 v124, v12
  v_mov_b32 v125, v13
  v_mov_b32 v126, v14
  v_mov_b32 v127, v15
  v_permlane32_swap_b32 v8, v120
  v_permlane32_swap_b32 v9, v121
  v_permlane32_swap_b32 v10, v122
  v_permlane32_swap_b32 v11, v123
  v_permlane32_swap_b32 v12, v124
  v_permlane32_swap_b32 v13, v125
  v_permlane32_swap_b32 v14, v126
  v_permlane32_swap_b32 v15, v127
  v_add_f32 v8, v8, v120
  v_add_f32 v9, v9, v121
  v_add_f32 v10, v10, v122
  v_add_f32 v11, v11, v123
  v_add_f32 v12, v12, v124
  v_add_f32 v13, v13, v125
  v_add_f32 v14, v14, v126
  v_add_f32 v15, v15, v127
  s_waitcnt vmcnt(3)
  v_cmp_eq_u32 vcc, 0, v115
  s_nop 3
  s_cmp_eq_u64 vcc, 0
  s_cbranch_scc1 L_pg_ok_n
  s_mov_b32 s20, 0
L_pg_poll_n:
  s_sleep 2
  s_xor_b32 s16, s2, 8
  s_lshl_b32 s16, s16, 3
  s_add_u32 s16, s16, 32768
  v_mov_b32 v118, 0
  buffer_load_dwordx2 v[114:115], v118, s[92:95], s16 offen sc1
  s_waitcnt vmcnt(0)
  v_cmp_eq_u32 vcc, 0, v115
  s_nop 3
  s_cmp_eq_u64 vcc, 0
  s_cbranch_scc1 L_pg_ok_n
  s_add_u32 s20, s20, 1
  s_cmp_lt_u32 s20, 100000
  s_cbranch_scc1 L_pg_poll_n
L_pg_ok_n:
  s_nop 1
  s_mov_b32 s16, 0x3fb8aa3b
  v_max_f32 v118, v112, v114
  v_sub_f32 v120, v112, v118
  v_sub_f32 v121, v114, v118
  v_sub_f32 v122, v116, v118
  v_mul_f32 v120, s16, v120
  v_mul_f32 v121, s16, v121
  v_mul_f32 v122, s16, v122
  v_exp_f32 v120, v120
  v_exp_f32 v121, v121
  v_exp_f32 v122, v122
  v_mul_f32 v120, v113, v120
  v_fmac_f32 v120, v115, v121
  v_rcp_f32 v124, v120
  s_nop 0
  v_fma_f32 v125, -v120, v124, 1.0
  v_fma_f32 v124, v125, v124, v124
  v_mul_f32 v123, v122, v124
  v_fma_f32 v125, -v123, v120, v122
  v_fma_f32 v123, v125, v124, v123
  v_mul_f32 v8, v8, v123
  v_mul_f32 v9, v9, v123
  v_mul_f32 v10, v10, v123
  v_mul_f32 v11, v11, v123
  v_mul_f32 v12, v12, v123
  v_mul_f32 v13, v13, v123
  v_mul_f32 v14, v14, v123
  v_mul_f32 v15, v15, v123
  s_lshl_b32 s16, s3, 9
  s_add_u32 s16, s16, 98304
  v_and_b32 v118, 15, v1
  v_lshlrev_b32 v118, 5, v118
  v_add_u32 v118, s16, v118
  ds_write_b128 v118, v[8:11]
  ds_write_b128 v118, v[12:15] offset:16
  s_waitcnt lgkmcnt(0)
  s_barrier
  s_lshl_b32 s16, s3, 5
  s_add_u32 s16, s16, 98304
  v_mov_b32 v118, s16
  ds_read_b128 v[8:11], v118
  ds_read_b128 v[12:15], v118 offset:16
  ds_read_b128 v[16:19], v118 offset:512
  ds_read_b128 v[20:23], v118 offset:528
  ds_read_b128 v[24:27], v118 offset:1024
  ds_read_b128 v[28:31], v118 offset:1040
  ds_read_b128 v[32:35], v118 offset:1536
  ds_read_b128 v[36:39], v118 offset:1552
  ds_read_b128 v[40:43], v118 offset:2048
  ds_read_b128 v[44:47], v118 offset:2064
  s_waitcnt lgkmcnt(0)
  v_add_f32 v8, v8, v16
  v_add_f32 v9, v9, v17
  v_add_f32 v10, v10, v18
  v_add_f32 v11, v11, v19
  v_add_f32 v12, v12, v20
  v_add_f32 v13, v13, v21
  v_add_f32 v14, v14, v22
  v_add_f32 v15, v15, v23
  v_add_f32 v8, v8, v24
  v_add_f32 v9, v9, v25
  v_add_f32 v10, v10, v26
  v_add_f32 v11, v11, v27
  v_add_f32 v12, v12, v28
  v_add_f32 v13, v13, v29
  v_add_f32 v14, v14, v30
  v_add_f32 v15, v15, v31
  v_add_f32 v8, v8, v32
  v_add_f32 v9, v9, v33
  v_add_f32 v10, v10, v34
  v_add_f32 v11, v11, v35
  v_add_f32 v12, v12, v36
  v_add_f32 v13, v13, v37
  v_add_f32 v14, v14, v38
  v_add_f32 v15, v15, v39
  v_add_f32 v8, v8, v40
  v_add_f32 v9, v9, v41
  v_add_f32 v10, v10, v42
  v_add_f32 v11, v11, v43
  v_add_f32 v12, v12, v44
  v_add_f32 v13, v13, v45
  v_add_f32 v14, v14, v46
  v_add_f32 v15, v15, v47
  ds_read_b128 v[16:19], v118 offset:2560
  ds_read_b128 v[20:23], v118 offset:2576
  ds_read_b128 v[24:27], v118 offset:3072
  ds_read_b128 v[28:31], v118 offset:3088
  ds_read_b128 v[32:35], v118 offset:3584
  ds_read_b128 v[36:39], v118 offset:3600
  ds_read_b128 v[40:43], v118 offset:4096
  ds_read_b128 v[44:47], v118 offset:4112
  s_waitcnt lgkmcnt(0)
  v_add_f32 v8, v8, v16
  v_add_f32 v9, v9, v17
  v_add_f32 v10, v10, v18
  v_add_f32 v11, v11, v19
  v_add_f32 v12, v12, v20
  v_add_f32 v13, v13, v21
  v_add_f32 v14, v14, v22
  v_add_f32 v15, v15, v23
  v_add_f32 v8, v8, v24
  v_add_f32 v9, v9, v25
  v_add_f32 v10, v10, v26
  v_add_f32 v11, v11, v27
  v_add_f32 v12, v12, v28
  v_add_f32 v13, v13, v29
  v_add_f32 v14, v14, v30
  v_add_f32 v15, v15, v31
  v_add_f32 v8, v8, v32
  v_add_f32 v9, v9, v33
  v_add_f32 v10, v10, v34
  v_add_f32 v11, v11, v35
  v_add_f32 v12, v12, v36
  v_add_f32 v13, v13, v37
  v_add_f32 v14, v14, v38
  v_add_f32 v15, v15, v39
  v_add_f32 v8, v8, v40
  v_add_f32 v9, v9, v41
  v_add_f32 v10, v10, v42
  v_add_f32 v11, v11, v43
  v_add_f32 v12, v12, v44
  v_add_f32 v13, v13, v45
  v_add_f32 v14, v14, v46
  v_add_f32 v15, v15, v47
  ds_read_b128 v[16:19], v118 offset:4608
  ds_read_b128 v[20:23], v118 offset:4624
  ds_read_b128 v[24:27], v118 offset:5120
  ds_read_b128 v[28:31], v118 offset:5136
  ds_read_b128 v[32:35], v118 offset:5632
  ds_read_b128 v[36:39], v118 offset:5648
  ds_read_b128 v[40:43], v118 offset:6144
  ds_read_b128 v[44:47], v118 offset:6160
  s_waitcnt lgkmcnt(0)
  v_add_f32 v8, v8, v16
  v_add_f32 v9, v9, v17
  v_add_f32 v10, v10, v18
  v_add_f32 v11, v11, v19
  v_add_f32 v12, v12, v20
  v_add_f32 v13, v13, v21
  v_add_f32 v14, v14, v22
  v_add_f32 v15, v15, v23
  v_add_f32 v8, v8, v24
  v_add_f32 v9, v9, v25
  v_add_f32 v10, v10, v26
  v_add_f32 v11, v11, v27
  v_add_f32 v12, v12, v28
  v_add_f32 v13, v13, v29
  v_add_f32 v14, v14, v30
  v_add_f32 v15, v15, v31
  v_add_f32 v8, v8, v32
  v_add_f32 v9, v9, v33
  v_add_f32 v10, v10, v34
  v_add_f32 v11, v11, v35
  v_add_f32 v12, v12, v36
  v_add_f32 v13, v13, v37
  v_add_f32 v14, v14, v38
  v_add_f32 v15, v15, v39
  v_add_f32 v8, v8, v40
  v_add_f32 v9, v9, v41
  v_add_f32 v10, v10, v42
  v_add_f32 v11, v11, v43
  v_add_f32 v12, v12, v44
  v_add_f32 v13, v13, v45
  v_add_f32 v14, v14, v46
  v_add_f32 v15, v15, v47
  ds_read_b128 v[16:19], v118 offset:6656
  ds_read_b128 v[20:23], v118 offset:6672
  ds_read_b128 v[24:27], v118 offset:7168
  ds_read_b128 v[28:31], v118 offset:7184
  ds_read_b128 v[32:35], v118 offset:7680
  ds_read_b128 v[36:39], v118 offset:7696
  s_waitcnt lgkmcnt(0)
  v_add_f32 v8, v8, v16
  v_add_f32 v9, v9, v17
  v_add_f32 v10, v10, v18
  v_add_f32 v11, v11, v19
  v_add_f32 v12, v12, v20
  v_add_f32 v13, v13, v21
  v_add_f32 v14, v14, v22
  v_add_f32 v15, v15, v23
  v_add_f32 v8, v8, v24
  v_add_f32 v9, v9, v25
  v_add_f32 v10, v10, v26
  v_add_f32 v11, v11, v27
  v_add_f32 v12, v12, v28
  v_add_f32 v13, v13, v29
  v_add_f32 v14, v14, v30
  v_add_f32 v15, v15, v31
  v_add_f32 v8, v8, v32
  v_add_f32 v9, v9, v33
  v_add_f32 v10, v10, v34
  v_add_f32 v11, v11, v35
  v_add_f32 v12, v12, v36
  v_add_f32 v13, v13, v37
  v_add_f32 v14, v14, v38
  v_add_f32 v15, v15, v39
  v_mov_b32 v16, 0
  v_mov_b32 v17, 0
  v_mov_b32 v18, 0
  v_mov_b32 v19, 0
  v_mov_b32 v20, 0
  v_mov_b32 v21, 0
  v_mov_b32 v22, 0
  v_mov_b32 v23, 0
  v_lshlrev_b32 v120, 16, v48
  v_and_b32 v121, 0xffff0000, v48
  v_lshlrev_b32 v122, 16, v49
  v_and_b32 v123, 0xffff0000, v49
  v_lshlrev_b32 v124, 16, v50
  v_and_b32 v125, 0xffff0000, v50
  v_lshlrev_b32 v126, 16, v51
  v_and_b32 v127, 0xffff0000, v51
  v_fmac_f32 v16, v8, v120
  v_fmac_f32 v17, v8, v121
  v_fmac_f32 v18, v8, v122
  v_fmac_f32 v19, v8, v123
  v_fmac_f32 v20, v8, v124
  v_fmac_f32 v21, v8, v125
  v_fmac_f32 v22, v8, v126
  v_fmac_f32 v23, v8, v127
  v_lshlrev_b32 v120, 16, v52
  v_and_b32 v121, 0xffff0000, v52
  v_lshlrev_b32 v122, 16, v53
  v_and_b32 v123, 0xffff0000, v53
  v_lshlrev_b32 v124, 16, v54
  v_and_b32 v125, 0xffff0000, v54
  v_lshlrev_b32 v126, 16, v55
  v_and_b32 v127, 0xffff0000, v55
  v_fmac_f32 v16, v9, v120
  v_fmac_f32 v17, v9, v121
  v_fmac_f32 v18, v9, v122
  v_fmac_f32 v19, v9, v123
  v_fmac_f32 v20, v9, v124
  v_fmac_f32 v21, v9, v125
  v_fmac_f32 v22, v9, v126
  v_fmac_f32 v23, v9, v127
  v_lshlrev_b32 v120, 16, v56
  v_and_b32 v121, 0xffff0000, v56
  v_lshlrev_b32 v122, 16, v57
  v_and_b32 v123, 0xffff0000, v57
  v_lshlrev_b32 v124, 16, v58
  v_and_b32 v125, 0xffff0000, v58
  v_lshlrev_b32 v126, 16, v59
  v_and_b32 v127, 0xffff0000, v59
  v_fmac_f32 v16, v10, v120
  v_fmac_f32 v17, v10, v121
  v_fmac_f32 v18, v10, v122
  v_fmac_f32 v19, v10, v123
  v_fmac_f32 v20, v10, v124
  v_fmac_f32 v21, v10, v125
  v_fmac_f32 v22, v10, v126
  v_fmac_f32 v23, v10, v127
  v_lshlrev_b32 v120, 16, v60
  v_and_b32 v121, 0xffff0000, v60
  v_lshlrev_b32 v122, 16, v61
  v_and_b32 v123, 0xffff0000, v61
  v_lshlrev_b32 v124, 16, v62
  v_and_b32 v125, 0xffff0000, v62
  v_lshlrev_b32 v126, 16, v63
  v_and_b32 v127, 0xffff0000, v63
  v_fmac_f32 v16, v11, v120
  v_fmac_f32 v17, v11, v121
  v_fmac_f32 v18, v11, v122
  v_fmac_f32 v19, v11, v123
  v_fmac_f32 v20, v11, v124
  v_fmac_f32 v21, v11, v125
  v_fmac_f32 v22, v11, v126
  v_fmac_f32 v23, v11, v127
  v_lshlrev_b32 v120, 16, v64
  v_and_b32 v121, 0xffff0000, v64
  v_lshlrev_b32 v122, 16, v65
  v_and_b32 v123, 0xffff0000, v65
  v_lshlrev_b32 v124, 16, v66
  v_and_b32 v125, 0xffff0000, v66
  v_lshlrev_b32 v126, 16, v67
  v_and_b32 v127, 0xffff0000, v67
  v_fmac_f32 v16, v12, v120
  v_fmac_f32 v17, v12, v121
  v_fmac_f32 v18, v12, v122
  v_fmac_f32 v19, v12, v123
  v_fmac_f32 v20, v12, v124
  v_fmac_f32 v21, v12, v125
  v_fmac_f32 v22, v12, v126
  v_fmac_f32 v23, v12, v127
  s_waitcnt vmcnt(2)
  v_lshlrev_b32 v120, 16, v68
  v_and_b32 v121, 0xffff0000, v68
  v_lshlrev_b32 v122, 16, v69
  v_and_b32 v123, 0xffff0000, v69
  v_lshlrev_b32 v124, 16, v70
  v_and_b32 v125, 0xffff0000, v70
  v_lshlrev_b32 v126, 16, v71
  v_and_b32 v127, 0xffff0000, v71
  v_fmac_f32 v16, v13, v120
  v_fmac_f32 v17, v13, v121
  v_fmac_f32 v18, v13, v122
  v_fmac_f32 v19, v13, v123
  v_fmac_f32 v20, v13, v124
  v_fmac_f32 v21, v13, v125
  v_fmac_f32 v22, v13, v126
  v_fmac_f32 v23, v13, v127
  s_waitcnt vmcnt(1)
  v_lshlrev_b32 v120, 16, v72
  v_and_b32 v121, 0xffff0000, v72
  v_lshlrev_b32 v122, 16, v73
  v_and_b32 v123, 0xffff0000, v73
  v_lshlrev_b32 v124, 16, v74
  v_and_b32 v125, 0xffff0000, v74
  v_lshlrev_b32 v126, 16, v75
  v_and_b32 v127, 0xffff0000, v75
  v_fmac_f32 v16, v14, v120
  v_fmac_f32 v17, v14, v121
  v_fmac_f32 v18, v14, v122
  v_fmac_f32 v19, v14, v123
  v_fmac_f32 v20, v14, v124
  v_fmac_f32 v21, v14, v125
  v_fmac_f32 v22, v14, v126
  v_fmac_f32 v23, v14, v127
  s_waitcnt vmcnt(0)
  v_lshlrev_b32 v120, 16, v76
  v_and_b32 v121, 0xffff0000, v76
  v_lshlrev_b32 v122, 16, v77
  v_and_b32 v123, 0xffff0000, v77
  v_lshlrev_b32 v124, 16, v78
  v_and_b32 v125, 0xffff0000, v78
  v_lshlrev_b32 v126, 16, v79
  v_and_b32 v127, 0xffff0000, v79
  v_fmac_f32 v16, v15, v120
  v_fmac_f32 v17, v15, v121
  v_fmac_f32 v18, v15, v122
  v_fmac_f32 v19, v15, v123
  v_fmac_f32 v20, v15, v124
  v_fmac_f32 v21, v15, v125
  v_fmac_f32 v22, v15, v126
  v_fmac_f32 v23, v15, v127
  s_lshl_b32 s16, s3, 11
  s_add_u32 s16, s16, 106496
  v_lshlrev_b32 v118, 5, v1
  v_add_u32 v118, s16, v118
  ds_write_b128 v118, v[16:19]
  ds_write_b128 v118, v[20:23] offset:16
  s_waitcnt lgkmcnt(0)
  s_barrier
  s_cmp_lt_u32 s3, 8
  s_cbranch_scc0 L_noatt_n
  v_lshlrev_b32 v118, 2, v0
  v_add_u32 v119, 106496, v118
  ds_read_b32 v8, v119
  ds_read_b32 v9, v119 offset:2048
  ds_read_b32 v10, v119 offset:4096
  ds_read_b32 v11, v119 offset:6144
  ds_read_b32 v12, v119 offset:8192
  ds_read_b32 v13, v119 offset:10240
  ds_read_b32 v14, v119 offset:12288
  ds_read_b32 v15, v119 offset:14336
  ds_read_b32 v16, v119 offset:16384
  ds_read_b32 v17, v119 offset:18432
  ds_read_b32 v18, v119 offset:20480
  ds_read_b32 v19, v119 offset:22528
  ds_read_b32 v20, v119 offset:24576
  ds_read_b32 v21, v119 offset:26624
  ds_read_b32 v22, v119 offset:28672
  ds_read_b32 v23, v119 offset:30720
  s_waitcnt lgkmcnt(0)
  v_add_f32 v8, v8, v9
  v_add_f32 v8, v8, v10
  v_add_f32 v8, v8, v11
  v_add_f32 v8, v8, v12
  v_add_f32 v8, v8, v13
  v_add_f32 v8, v8, v14
  v_add_f32 v8, v8, v15
  v_add_f32 v8, v8, v16
  v_add_f32 v8, v8, v17
  v_add_f32 v8, v8, v18
  v_add_f32 v8, v8, v19
  v_add_f32 v8, v8, v20
  v_add_f32 v8, v8, v21
  v_add_f32 v8, v8, v22
  v_add_f32 v8, v8, v23
  s_lshl_b32 s16, s96, 11
  s_add_u32 s16, s16, 40960
  buffer_atomic_add_f32 v8, v118, s[92:95], s16 offen
  s_waitcnt vmcnt(0)
L_noatt_n:
  s_nop 1
  s_barrier
  s_cmp_eq_u32 s3, 0
  s_cbranch_scc0 L_nosig_n
  s_and_b32 s16, s2, 7
  s_lshl_b32 s16, s16, 7
  s_add_u32 s16, s16, 36864
  v_mov_b32 v8, 1
  v_mov_b32 v9, 0
  s_mov_b64 exec, 1
  buffer_atomic_add v8, v9, s[92:95], s16 offen
  s_mov_b64 exec, -1
L_nosig_n:
  s_nop 1
  s_branch L_WORK
L_WORK:
  s_sub_u32 s18, s2, 96
  s_cmp_lt_u32 s18, 56
  s_cbranch_scc0 L_END
  s_cmp_lt_u32 s3, 4
  s_cbranch_scc0 L_w_nopf
  s_mul_i32 s16, s3, 6144
  buffer_load_dwordx4 v[16:19], v2, s[92:95], s16 offen offset:2048
  buffer_load_dwordx4 v[20:23], v2, s[92:95], s16 offen offset:3072
  s_add_u32 s16, s16, 4096
  buffer_load_dwordx4 v[24:27], v2, s[92:95], s16 offen
  s_lshl_b32 s16, s3, 10
  buffer_load_dwordx4 v[28:31], v2, s[44:47], s16 offen
L_w_nopf:
  s_nop 1
  s_cmp_eq_u32 s3, 0
  s_cbranch_scc0 L_w_nopoll
  v_and_b32 v125, 7, v1
  v_lshlrev_b32 v125, 7, v125
  v_add_u32 v125, 36864, v125
  s_mov_b32 s20, 0
L_f2:
  s_nop 1
  buffer_load_dword v126, v125, s[92:95], 0 offen sc1
  s_waitcnt vmcnt(0)
  v_cmp_eq_u32 vcc, 32, v126
  s_nop 3
  s_cmp_eq_u64 vcc, -1
  s_cbranch_scc1 L_f2_ok
  s_add_u32 s20, s20, 1
  s_cmp_ge_u32 s20, 2000000
  s_cbranch_scc1 L_f2_ok
  s_branch L_f2
L_f2_ok:
  s_nop 1
L_w_nopoll:
  s_barrier
  s_cmp_lt_u32 s3, 4
  s_cbranch_scc0 L_w_noln
  v_lshlrev_b32 v3, 5, v1
  s_lshl_b32 s16, s3, 11
  s_add_u32 s16, s16, 40960
  buffer_load_dwordx4 v[8:11], v3, s[92:95], s16 offen sc1
  buffer_load_dwordx4 v[12:15], v3, s[92:95], s16 offen offset:16 sc1
  s_waitcnt vmcnt(0)
  v_lshlrev_b32 v32, 16, v16
  v_and_b32 v33, 0xffff0000, v16
  v_lshlrev_b32 v34, 16, v17
  v_and_b32 v35, 0xffff0000, v17
  v_lshlrev_b32 v36, 16, v18
  v_and_b32 v37, 0xffff0000, v18
  v_lshlrev_b32 v38, 16, v19
  v_and_b32 v39, 0xffff0000, v19
  v_lshlrev_b32 v40, 16, v20
  v_and_b32 v41, 0xffff0000, v20
  v_lshlrev_b32 v42, 16, v21
  v_and_b32 v43, 0xffff0000, v21
  v_lshlrev_b32 v44, 16, v22
  v_and_b32 v45, 0xffff0000, v22
  v_lshlrev_b32 v46, 16, v23
  v_and_b32 v47, 0xffff0000, v23
  v_lshlrev_b32 v48, 16, v24
  v_and_b32 v49, 0xffff0000, v24
  v_lshlrev_b32 v50, 16, v25
  v_and_b32 v51, 0xffff0000, v25
  v_lshlrev_b32 v52, 16, v26
  v_and_b32 v53, 0xffff0000, v26
  v_lshlrev_b32 v54, 16, v27
  v_and_b32 v55, 0xffff0000, v27
  v_lshlrev_b32 v56, 16, v28
  v_and_b32 v57, 0xffff0000, v28
  v_lshlrev_b32 v58, 16, v29
  v_and_b32 v59, 0xffff0000, v29
  v_lshlrev_b32 v60, 16, v30
  v_and_b32 v61, 0xffff0000, v30
  v_lshlrev_b32 v62, 16, v31
  v_and_b32 v63, 0xffff0000, v31
  v_cvt_pk_bf16_f32 v8, v8, v8
  v_and_b32 v8, 0xffff0000, v8
  v_cvt_pk_bf16_f32 v9, v9, v9
  v_and_b32 v9, 0xffff0000, v9
  v_cvt_pk_bf16_f32 v10, v10, v10
  v_and_b32 v10, 0xffff0000, v10
  v_cvt_pk_bf16_f32 v11, v11, v11
  v_and_b32 v11, 0xffff0000, v11
  v_cvt_pk_bf16_f32 v12, v12, v12
  v_and_b32 v12, 0xffff0000, v12
  v_cvt_pk_bf16_f32 v13, v13, v13
  v_and_b32 v13, 0xffff0000, v13
  v_cvt_pk_bf16_f32 v14, v14, v14
  v_and_b32 v14, 0xffff0000, v14
  v_cvt_pk_bf16_f32 v15, v15, v15
  v_and_b32 v15, 0xffff0000, v15
  v_mul_f32 v8, v8, v32
  v_mul_f32 v9, v9, v33
  v_mul_f32 v10, v10, v34
  v_mul_f32 v11, v11, v35
  v_mul_f32 v12, v12, v36
  v_mul_f32 v13, v13, v37
  v_mul_f32 v14, v14, v38
  v_mul_f32 v15, v15, v39
  v_cvt_pk_bf16_f32 v8, v8, v8
  v_and_b32 v8, 0xffff0000, v8
  v_cvt_pk_bf16_f32 v9, v9, v9
  v_and_b32 v9, 0xffff0000, v9
  v_cvt_pk_bf16_f32 v10, v10, v10
  v_and_b32 v10, 0xffff0000, v10
  v_cvt_pk_bf16_f32 v11, v11, v11
  v_and_b32 v11, 0xffff0000, v11
  v_cvt_pk_bf16_f32 v12, v12, v12
  v_and_b32 v12, 0xffff0000, v12
  v_cvt_pk_bf16_f32 v13, v13, v13
  v_and_b32 v13, 0xffff0000, v13
  v_cvt_pk_bf16_f32 v14, v14, v14
  v_and_b32 v14, 0xffff0000, v14
  v_cvt_pk_bf16_f32 v15, v15, v15
  v_and_b32 v15, 0xffff0000, v15
  v_add_f32 v8, v8, v56
  v_add_f32 v9, v9, v57
  v_add_f32 v10, v10, v58
  v_add_f32 v11, v11, v59
  v_add_f32 v12, v12, v60
  v_add_f32 v13, v13, v61
  v_add_f32 v14, v14, v62
  v_add_f32 v15, v15, v63
  v_cvt_pk_bf16_f32 v8, v8, v8
  v_and_b32 v8, 0xffff0000, v8
  v_cvt_pk_bf16_f32 v9, v9, v9
  v_and_b32 v9, 0xffff0000, v9
  v_cvt_pk_bf16_f32 v10, v10, v10
  v_and_b32 v10, 0xffff0000, v10
  v_cvt_pk_bf16_f32 v11, v11, v11
  v_and_b32 v11, 0xffff0000, v11
  v_cvt_pk_bf16_f32 v12, v12, v12
  v_and_b32 v12, 0xffff0000, v12
  v_cvt_pk_bf16_f32 v13, v13, v13
  v_and_b32 v13, 0xffff0000, v13
  v_cvt_pk_bf16_f32 v14, v14, v14
  v_and_b32 v14, 0xffff0000, v14
  v_cvt_pk_bf16_f32 v15, v15, v15
  v_and_b32 v15, 0xffff0000, v15
  s_lshl_b32 s16, s3, 11
  s_add_u32 s16, s16, 98304
  v_add_u32 v64, s16, v3
  ds_write_b128 v64, v[8:11]
  ds_write_b128 v64, v[12:15] offset:16
  v_add_f32 v64, v8, v9
  v_add_f32 v64, v64, v10
  v_add_f32 v64, v64, v11
  v_add_f32 v64, v64, v12
  v_add_f32 v64, v64, v13
  v_add_f32 v64, v64, v14
  v_add_f32 v64, v64, v15
  s_nop 1
  v_add_f32_dpp v64, v64, v64 row_ror:8 row_mask:0xf bank_mask:0xf
  s_nop 1
  v_add_f32_dpp v64, v64, v64 row_ror:4 row_mask:0xf bank_mask:0xf
  s_nop 1
  v_add_f32_dpp v64, v64, v64 row_ror:2 row_mask:0xf bank_mask:0xf
  s_nop 1
  v_add_f32_dpp v64, v64, v64 row_ror:1 row_mask:0xf bank_mask:0xf
  v_mov_b32 v74, v64
  s_nop 1
  v_permlane16_swap_b32 v64, v74
  v_add_f32 v64, v64, v74
  v_mov_b32 v74, v64
  s_nop 1
  v_permlane32_swap_b32 v64, v74
  v_add_f32 v64, v64, v74
  v_mul_f32 v65, 0x3b000000, v64
  v_sub_f32 v66, v8, v65
  v_sub_f32 v67, v9, v65
  v_sub_f32 v68, v10, v65
  v_sub_f32 v69, v11, v65
  v_sub_f32 v70, v12, v65
  v_sub_f32 v71, v13, v65
  v_sub_f32 v72, v14, v65
  v_sub_f32 v73, v15, v65
  v_mul_f32 v64, v66, v66
  v_fmac_f32 v64, v67, v67
  v_fmac_f32 v64, v68, v68
  v_fmac_f32 v64, v69, v69
  v_fmac_f32 v64, v70, v70
  v_fmac_f32 v64, v71, v71
  v_fmac_f32 v64, v72, v72
  v_fmac_f32 v64, v73, v73
  s_nop 1
  v_add_f32_dpp v64, v64, v64 row_ror:8 row_mask:0xf bank_mask:0xf
  s_nop 1
  v_add_f32_dpp v64, v64, v64 row_ror:4 row_mask:0xf bank_mask:0xf
  s_nop 1
  v_add_f32_dpp v64, v64, v64 row_ror:2 row_mask:0xf bank_mask:0xf
  s_nop 1
  v_add_f32_dpp v64, v64, v64 row_ror:1 row_mask:0xf bank_mask:0xf
  v_mov_b32 v74, v64
  s_nop 1
  v_permlane16_swap_b32 v64, v74
  v_add_f32 v64, v64, v74
  v_mov_b32 v74, v64
  s_nop 1
  v_permlane32_swap_b32 v64, v74
  v_add_f32 v64, v64, v74
  v_mul_f32 v64, 0x3b000000, v64
  v_cvt_pk_bf16_f32 v64, v64, v64
  v_and_b32 v64, 0xffff0000, v64
  v_add_f32 v64, 0x3727c5ac, v64
  v_cvt_pk_bf16_f32 v64, v64, v64
  v_and_b32 v64, 0xffff0000, v64
  v_sqrt_f32 v64, v64
  s_nop 0
  v_cvt_pk_bf16_f32 v64, v64, v64
  v_and_b32 v64, 0xffff0000, v64
  v_cvt_pk_bf16_f32 v65, v65, v65
  v_and_b32 v65, 0xffff0000, v65
  v_sub_f32 v66, v8, v65
  v_sub_f32 v67, v9, v65
  v_sub_f32 v68, v10, v65
  v_sub_f32 v69, v11, v65
  v_sub_f32 v70, v12, v65
  v_sub_f32 v71, v13, v65
  v_sub_f32 v72, v14, v65
  v_sub_f32 v73, v15, v65
  v_cvt_pk_bf16_f32 v66, v66, v66
  v_and_b32 v66, 0xffff0000, v66
  v_cvt_pk_bf16_f32 v67, v67, v67
  v_and_b32 v67, 0xffff0000, v67
  v_cvt_pk_bf16_f32 v68, v68, v68
  v_and_b32 v68, 0xffff0000, v68
  v_cvt_pk_bf16_f32 v69, v69, v69
  v_and_b32 v69, 0xffff0000, v69
  v_cvt_pk_bf16_f32 v70, v70, v70
  v_and_b32 v70, 0xffff0000, v70
  v_cvt_pk_bf16_f32 v71, v71, v71
  v_and_b32 v71, 0xffff0000, v71
  v_cvt_pk_bf16_f32 v72, v72, v72
  v_and_b32 v72, 0xffff0000, v72
  v_cvt_pk_bf16_f32 v73, v73, v73
  v_and_b32 v73, 0xffff0000, v73
  v_rcp_f32 v74, v64
  s_nop 0
  v_fma_f32 v75, -v64, v74, 1.0
  v_fma_f32 v74, v75, v74, v74
  v_mul_f32 v8, v66, v74
  v_fma_f32 v75, -v8, v64, v66
  v_fma_f32 v8, v75, v74, v8
  v_rcp_f32 v74, v64
  s_nop 0
  v_fma_f32 v75, -v64, v74, 1.0
  v_fma_f32 v74, v75, v74, v74
  v_mul_f32 v9, v67, v74
  v_fma_f32 v75, -v9, v64, v67
  v_fma_f32 v9, v75, v74, v9
  v_rcp_f32 v74, v64
  s_nop 0
  v_fma_f32 v75, -v64, v74, 1.0
  v_fma_f32 v74, v75, v74, v74
  v_mul_f32 v10, v68, v74
  v_fma_f32 v75, -v10, v64, v68
  v_fma_f32 v10, v75, v74, v10
  v_rcp_f32 v74, v64
  s_nop 0
  v_fma_f32 v75, -v64, v74, 1.0
  v_fma_f32 v74, v75, v74, v74
  v_mul_f32 v11, v69, v74
  v_fma_f32 v75, -v11, v64, v69
  v_fma_f32 v11, v75, v74, v11
  v_rcp_f32 v74, v64
  s_nop 0
  v_fma_f32 v75, -v64, v74, 1.0
  v_fma_f32 v74, v75, v74, v74
  v_mul_f32 v12, v70, v74
  v_fma_f32 v75, -v12, v64, v70
  v_fma_f32 v12, v75, v74, v12
  v_rcp_f32 v74, v64
  s_nop 0
  v_fma_f32 v75, -v64, v74, 1.0
  v_fma_f32 v74, v75, v74, v74
  v_mul_f32 v13, v71, v74
  v_fma_f32 v75, -v13, v64, v71
  v_fma_f32 v13, v75, v74, v13
  v_rcp_f32 v74, v64
  s_nop 0
  v_fma_f32 v75, -v64, v74, 1.0
  v_fma_f32 v74, v75, v74, v74
  v_mul_f32 v14, v72, v74
  v_fma_f32 v75, -v14, v64, v72
  v_fma_f32 v14, v75, v74, v14
  v_rcp_f32 v74, v64
  s_nop 0
  v_fma_f32 v75, -v64, v74, 1.0
  v_fma_f32 v74, v75, v74, v74
  v_mul_f32 v15, v73, v74
  v_fma_f32 v75, -v15, v64, v73
  v_fma_f32 v15, v75, v74, v15
  v_cvt_pk_bf16_f32 v8, v8, v8
  v_and_b32 v8, 0xffff0000, v8
  v_cvt_pk_bf16_f32 v9, v9, v9
  v_and_b32 v9, 0xffff0000, v9
  v_cvt_pk_bf16_f32 v10, v10, v10
  v_and_b32 v10, 0xffff0000, v10
  v_cvt_pk_bf16_f32 v11, v11, v11
  v_and_b32 v11, 0xffff0000, v11
  v_cvt_pk_bf16_f32 v12, v12, v12
  v_and_b32 v12, 0xffff0000, v12
  v_cvt_pk_bf16_f32 v13, v13, v13
  v_and_b32 v13, 0xffff0000, v13
  v_cvt_pk_bf16_f32 v14, v14, v14
  v_and_b32 v14, 0xffff0000, v14
  v_cvt_pk_bf16_f32 v15, v15, v15
  v_and_b32 v15, 0xffff0000, v15
  v_add_f32 v48, 1.0, v48
  v_add_f32 v49, 1.0, v49
  v_add_f32 v50, 1.0, v50
  v_add_f32 v51, 1.0, v51
  v_add_f32 v52, 1.0, v52
  v_add_f32 v53, 1.0, v53
  v_add_f32 v54, 1.0, v54
  v_add_f32 v55, 1.0, v55
  v_cvt_pk_bf16_f32 v48, v48, v48
  v_and_b32 v48, 0xffff0000, v48
  v_cvt_pk_bf16_f32 v49, v49, v49
  v_and_b32 v49, 0xffff0000, v49
  v_cvt_pk_bf16_f32 v50, v50, v50
  v_and_b32 v50, 0xffff0000, v50
  v_cvt_pk_bf16_f32 v51, v51, v51
  v_and_b32 v51, 0xffff0000, v51
  v_cvt_pk_bf16_f32 v52, v52, v52
  v_and_b32 v52, 0xffff0000, v52
  v_cvt_pk_bf16_f32 v53, v53, v53
  v_and_b32 v53, 0xffff0000, v53
  v_cvt_pk_bf16_f32 v54, v54, v54
  v_and_b32 v54, 0xffff0000, v54
  v_cvt_pk_bf16_f32 v55, v55, v55
  v_and_b32 v55, 0xffff0000, v55
  v_mul_f32 v8, v8, v48
  v_mul_f32 v9, v9, v49
  v_mul_f32 v10, v10, v50
  v_mul_f32 v11, v11, v51
  v_mul_f32 v12, v12, v52
  v_mul_f32 v13, v13, v53
  v_mul_f32 v14, v14, v54
  v_mul_f32 v15, v15, v55
  v_cvt_pk_bf16_f32 v8, v8, v8
  v_and_b32 v8, 0xffff0000, v8
  v_cvt_pk_bf16_f32 v9, v9, v9
  v_and_b32 v9, 0xffff0000, v9
  v_cvt_pk_bf16_f32 v10, v10, v10
  v_and_b32 v10, 0xffff0000, v10
  v_cvt_pk_bf16_f32 v11, v11, v11
  v_and_b32 v11, 0xffff0000, v11
  v_cvt_pk_bf16_f32 v12, v12, v12
  v_and_b32 v12, 0xffff0000, v12
  v_cvt_pk_bf16_f32 v13, v13, v13
  v_and_b32 v13, 0xffff0000, v13
  v_cvt_pk_bf16_f32 v14, v14, v14
  v_and_b32 v14, 0xffff0000, v14
  v_cvt_pk_bf16_f32 v15, v15, v15
  v_and_b32 v15, 0xffff0000, v15
  v_add_f32 v8, v8, v40
  v_add_f32 v9, v9, v41
  v_add_f32 v10, v10, v42
  v_add_f32 v11, v11, v43
  v_add_f32 v12, v12, v44
  v_add_f32 v13, v13, v45
  v_add_f32 v14, v14, v46
  v_add_f32 v15, v15, v47
  v_cvt_pk_bf16_f32 v8, v8, v8
  v_and_b32 v8, 0xffff0000, v8
  v_cvt_pk_bf16_f32 v9, v9, v9
  v_and_b32 v9, 0xffff0000, v9
  v_cvt_pk_bf16_f32 v10, v10, v10
  v_and_b32 v10, 0xffff0000, v10
  v_cvt_pk_bf16_f32 v11, v11, v11
  v_and_b32 v11, 0xffff0000, v11
  v_cvt_pk_bf16_f32 v12, v12, v12
  v_and_b32 v12, 0xffff0000, v12
  v_cvt_pk_bf16_f32 v13, v13, v13
  v_and_b32 v13, 0xffff0000, v13
  v_cvt_pk_bf16_f32 v14, v14, v14
  v_and_b32 v14, 0xffff0000, v14
  v_cvt_pk_bf16_f32 v15, v15, v15
  v_and_b32 v15, 0xffff0000, v15
  s_lshl_b32 s16, s3, 2
  s_add_u32 s16, s16, 139264
  v_lshlrev_b32 v64, 7, v1
  v_add_u32 v64, s16, v64
  ds_write_b32 v64, v8 offset:0
  ds_write_b32 v64, v9 offset:16
  ds_write_b32 v64, v10 offset:32
  ds_write_b32 v64, v11 offset:48
  ds_write_b32 v64, v12 offset:64
  ds_write_b32 v64, v13 offset:80
  ds_write_b32 v64, v14 offset:96
  ds_write_b32 v64, v15 offset:112
  s_waitcnt lgkmcnt(0)
L_w_noln:
  s_barrier
  v_and_b32 v3, 31, v0
  v_lshrrev_b32 v4, 5, v0
  v_and_b32 v5, 15, v3
  v_lshlrev_b32 v5, 2, v5
  v_lshl_add_u32 v5, v4, 10, v5
  v_lshrrev_b32 v6, 4, v3
  v_lshlrev_b32 v6, 15, v6
  v_add_u32 v5, v5, v6
  v_lshlrev_b32 v6, 8, v4
  v_add_u32 v6, 139264, v6
  v_mov_b32 v8, 0
  v_mov_b32 v9, 0
  v_mov_b32 v10, 0
  v_mov_b32 v11, 0
  v_mov_b32 v12, 0
  v_mov_b32 v13, 0
  v_mov_b32 v14, 0
  v_mov_b32 v15, 0
  ds_read_b32 v16, v5 offset:0
  ds_read_b128 v[24:27], v6 offset:0
  ds_read_b32 v17, v5 offset:64
  ds_read_b128 v[28:31], v6 offset:16
  ds_read_b32 v18, v5 offset:128
  ds_read_b128 v[32:35], v6 offset:32
  ds_read_b32 v19, v5 offset:192
  ds_read_b128 v[36:39], v6 offset:48
  s_waitcnt lgkmcnt(0)
  v_lshlrev_b32 v20, 16, v16
  v_and_b32 v21, 0xffff0000, v16
  v_fmac_f32 v8, v24, v20
  v_fmac_f32 v9, v24, v21
  v_fmac_f32 v10, v25, v20
  v_fmac_f32 v11, v25, v21
  v_fmac_f32 v12, v26, v20
  v_fmac_f32 v13, v26, v21
  v_fmac_f32 v14, v27, v20
  v_fmac_f32 v15, v27, v21
  v_lshlrev_b32 v20, 16, v17
  v_and_b32 v21, 0xffff0000, v17
  v_fmac_f32 v8, v28, v20
  v_fmac_f32 v9, v28, v21
  v_fmac_f32 v10, v29, v20
  v_fmac_f32 v11, v29, v21
  v_fmac_f32 v12, v30, v20
  v_fmac_f32 v13, v30, v21
  v_fmac_f32 v14, v31, v20
  v_fmac_f32 v15, v31, v21
  v_lshlrev_b32 v20, 16, v18
  v_and_b32 v21, 0xffff0000, v18
  v_fmac_f32 v8, v32, v20
  v_fmac_f32 v9, v32, v21
  v_fmac_f32 v10, v33, v20
  v_fmac_f32 v11, v33, v21
  v_fmac_f32 v12, v34, v20
  v_fmac_f32 v13, v34, v21
  v_fmac_f32 v14, v35, v20
  v_fmac_f32 v15, v35, v21
  v_lshlrev_b32 v20, 16, v19
  v_and_b32 v21, 0xffff0000, v19
  v_fmac_f32 v8, v36, v20
  v_fmac_f32 v9, v36, v21
  v_fmac_f32 v10, v37, v20
  v_fmac_f32 v11, v37, v21
  v_fmac_f32 v12, v38, v20
  v_fmac_f32 v13, v38, v21
  v_fmac_f32 v14, v39, v20
  v_fmac_f32 v15, v39, v21
  ds_read_b32 v16, v5 offset:256
  ds_read_b128 v[24:27], v6 offset:64
  ds_read_b32 v17, v5 offset:320
  ds_read_b128 v[28:31], v6 offset:80
  ds_read_b32 v18, v5 offset:384
  ds_read_b128 v[32:35], v6 offset:96
  ds_read_b32 v19, v5 offset:448
  ds_read_b128 v[36:39], v6 offset:112
  s_waitcnt lgkmcnt(0)
  v_lshlrev_b32 v20, 16, v16
  v_and_b32 v21, 0xffff0000, v16
  v_fmac_f32 v8, v24, v20
  v_fmac_f32 v9, v24, v21
  v_fmac_f32 v10, v25, v20
  v_fmac_f32 v11, v25, v21
  v_fmac_f32 v12, v26, v20
  v_fmac_f32 v13, v26, v21
  v_fmac_f32 v14, v27, v20
  v_fmac_f32 v15, v27, v21
  v_lshlrev_b32 v20, 16, v17
  v_and_b32 v21, 0xffff0000, v17
  v_fmac_f32 v8, v28, v20
  v_fmac_f32 v9, v28, v21
  v_fmac_f32 v10, v29, v20
  v_fmac_f32 v11, v29, v21
  v_fmac_f32 v12, v30, v20
  v_fmac_f32 v13, v30, v21
  v_fmac_f32 v14, v31, v20
  v_fmac_f32 v15, v31, v21
  v_lshlrev_b32 v20, 16, v18
  v_and_b32 v21, 0xffff0000, v18
  v_fmac_f32 v8, v32, v20
  v_fmac_f32 v9, v32, v21
  v_fmac_f32 v10, v33, v20
  v_fmac_f32 v11, v33, v21
  v_fmac_f32 v12, v34, v20
  v_fmac_f32 v13, v34, v21
  v_fmac_f32 v14, v35, v20
  v_fmac_f32 v15, v35, v21
  v_lshlrev_b32 v20, 16, v19
  v_and_b32 v21, 0xffff0000, v19
  v_fmac_f32 v8, v36, v20
  v_fmac_f32 v9, v36, v21
  v_fmac_f32 v10, v37, v20
  v_fmac_f32 v11, v37, v21
  v_fmac_f32 v12, v38, v20
  v_fmac_f32 v13, v38, v21
  v_fmac_f32 v14, v39, v20
  v_fmac_f32 v15, v39, v21
  ds_read_b32 v16, v5 offset:512
  ds_read_b128 v[24:27], v6 offset:128
  ds_read_b32 v17, v5 offset:576
  ds_read_b128 v[28:31], v6 offset:144
  ds_read_b32 v18, v5 offset:640
  ds_read_b128 v[32:35], v6 offset:160
  ds_read_b32 v19, v5 offset:704
  ds_read_b128 v[36:39], v6 offset:176
  s_waitcnt lgkmcnt(0)
  v_lshlrev_b32 v20, 16, v16
  v_and_b32 v21, 0xffff0000, v16
  v_fmac_f32 v8, v24, v20
  v_fmac_f32 v9, v24, v21
  v_fmac_f32 v10, v25, v20
  v_fmac_f32 v11, v25, v21
  v_fmac_f32 v12, v26, v20
  v_fmac_f32 v13, v26, v21
  v_fmac_f32 v14, v27, v20
  v_fmac_f32 v15, v27, v21
  v_lshlrev_b32 v20, 16, v17
  v_and_b32 v21, 0xffff0000, v17
  v_fmac_f32 v8, v28, v20
  v_fmac_f32 v9, v28, v21
  v_fmac_f32 v10, v29, v20
  v_fmac_f32 v11, v29, v21
  v_fmac_f32 v12, v30, v20
  v_fmac_f32 v13, v30, v21
  v_fmac_f32 v14, v31, v20
  v_fmac_f32 v15, v31, v21
  v_lshlrev_b32 v20, 16, v18
  v_and_b32 v21, 0xffff0000, v18
  v_fmac_f32 v8, v32, v20
  v_fmac_f32 v9, v32, v21
  v_fmac_f32 v10, v33, v20
  v_fmac_f32 v11, v33, v21
  v_fmac_f32 v12, v34, v20
  v_fmac_f32 v13, v34, v21
  v_fmac_f32 v14, v35, v20
  v_fmac_f32 v15, v35, v21
  v_lshlrev_b32 v20, 16, v19
  v_and_b32 v21, 0xffff0000, v19
  v_fmac_f32 v8, v36, v20
  v_fmac_f32 v9, v36, v21
  v_fmac_f32 v10, v37, v20
  v_fmac_f32 v11, v37, v21
  v_fmac_f32 v12, v38, v20
  v_fmac_f32 v13, v38, v21
  v_fmac_f32 v14, v39, v20
  v_fmac_f32 v15, v39, v21
  ds_read_b32 v16, v5 offset:768
  ds_read_b128 v[24:27], v6 offset:192
  ds_read_b32 v17, v5 offset:832
  ds_read_b128 v[28:31], v6 offset:208
  ds_read_b32 v18, v5 offset:896
  ds_read_b128 v[32:35], v6 offset:224
  ds_read_b32 v19, v5 offset:960
  ds_read_b128 v[36:39], v6 offset:240
  s_waitcnt lgkmcnt(0)
  v_lshlrev_b32 v20, 16, v16
  v_and_b32 v21, 0xffff0000, v16
  v_fmac_f32 v8, v24, v20
  v_fmac_f32 v9, v24, v21
  v_fmac_f32 v10, v25, v20
  v_fmac_f32 v11, v25, v21
  v_fmac_f32 v12, v26, v20
  v_fmac_f32 v13, v26, v21
  v_fmac_f32 v14, v27, v20
  v_fmac_f32 v15, v27, v21
  v_lshlrev_b32 v20, 16, v17
  v_and_b32 v21, 0xffff0000, v17
  v_fmac_f32 v8, v28, v20
  v_fmac_f32 v9, v28, v21
  v_fmac_f32 v10, v29, v20
  v_fmac_f32 v11, v29, v21
  v_fmac_f32 v12, v30, v20
  v_fmac_f32 v13, v30, v21
  v_fmac_f32 v14, v31, v20
  v_fmac_f32 v15, v31, v21
  v_lshlrev_b32 v20, 16, v18
  v_and_b32 v21, 0xffff0000, v18
  v_fmac_f32 v8, v32, v20
  v_fmac_f32 v9, v32, v21
  v_fmac_f32 v10, v33, v20
  v_fmac_f32 v11, v33, v21
  v_fmac_f32 v12, v34, v20
  v_fmac_f32 v13, v34, v21
  v_fmac_f32 v14, v35, v20
  v_fmac_f32 v15, v35, v21
  v_lshlrev_b32 v20, 16, v19
  v_and_b32 v21, 0xffff0000, v19
  v_fmac_f32 v8, v36, v20
  v_fmac_f32 v9, v36, v21
  v_fmac_f32 v10, v37, v20
  v_fmac_f32 v11, v37, v21
  v_fmac_f32 v12, v38, v20
  v_fmac_f32 v13, v38, v21
  v_fmac_f32 v14, v39, v20
  v_fmac_f32 v15, v39, v21
  v_mov_b32 v40, v8
  v_mov_b32 v41, v9
  v_mov_b32 v42, v10
  v_mov_b32 v43, v11
  v_mov_b32 v44, v12
  v_mov_b32 v45, v13
  v_mov_b32 v46, v14
  v_mov_b32 v47, v15
  v_permlane32_swap_b32 v8, v40
  v_permlane32_swap_b32 v9, v41
  v_permlane32_swap_b32 v10, v42
  v_permlane32_swap_b32 v11, v43
  v_permlane32_swap_b32 v12, v44
  v_permlane32_swap_b32 v13, v45
  v_permlane32_swap_b32 v14, v46
  v_permlane32_swap_b32 v15, v47
  v_add_f32 v8, v8, v40
  v_add_f32 v9, v9, v41
  v_add_f32 v10, v10, v42
  v_add_f32 v11, v11, v43
  v_add_f32 v12, v12, v44
  v_add_f32 v13, v13, v45
  v_add_f32 v14, v14, v46
  v_add_f32 v15, v15, v47
  s_lshl_b32 s16, s3, 10
  s_add_u32 s16, s16, 106496
  v_lshlrev_b32 v5, 5, v3
  v_add_u32 v5, s16, v5
  ds_write_b128 v5, v[8:11]
  ds_write_b128 v5, v[12:15] offset:16
  s_waitcnt lgkmcnt(0)
  s_barrier
  s_cmp_eq_u32 s3, 0
  s_cbranch_scc0 L_w_noact
  v_and_b32 v3, 15, v1
  v_lshrrev_b32 v4, 4, v1
  v_lshlrev_b32 v5, 5, v3
  v_lshl_add_u32 v5, v4, 3, v5
  v_add_u32 v5, 106496, v5
  ds_read_b64 v[8:9], v5
  ds_read_b64 v[10:11], v5 offset:512
  ds_read_b64 v[16:17], v5 offset:1024
  ds_read_b64 v[18:19], v5 offset:1536
  ds_read_b64 v[20:21], v5 offset:2048
  ds_read_b64 v[22:23], v5 offset:2560
  ds_read_b64 v[24:25], v5 offset:3072
  ds_read_b64 v[26:27], v5 offset:3584
  ds_read_b64 v[28:29], v5 offset:4096
  ds_read_b64 v[30:31], v5 offset:4608
  s_waitcnt lgkmcnt(0)
  v_add_f32 v8, v8, v16
  v_add_f32 v9, v9, v17
  v_add_f32 v10, v10, v18
  v_add_f32 v11, v11, v19
  v_add_f32 v8, v8, v20
  v_add_f32 v9, v9, v21
  v_add_f32 v10, v10, v22
  v_add_f32 v11, v11, v23
  v_add_f32 v8, v8, v24
  v_add_f32 v9, v9, v25
  v_add_f32 v10, v10, v26
  v_add_f32 v11, v11, v27
  v_add_f32 v8, v8, v28
  v_add_f32 v9, v9, v29
  v_add_f32 v10, v10, v30
  v_add_f32 v11, v11, v31
  ds_read_b64 v[16:17], v5 offset:5120
  ds_read_b64 v[18:19], v5 offset:5632
  ds_read_b64 v[20:21], v5 offset:6144
  ds_read_b64 v[22:23], v5 offset:6656
  ds_read_b64 v[24:25], v5 offset:7168
  ds_read_b64 v[26:27], v5 offset:7680
  ds_read_b64 v[28:29], v5 offset:8192
  ds_read_b64 v[30:31], v5 offset:8704
  s_waitcnt lgkmcnt(0)
  v_add_f32 v8, v8, v16
  v_add_f32 v9, v9, v17
  v_add_f32 v10, v10, v18
  v_add_f32 v11, v11, v19
  v_add_f32 v8, v8, v20
  v_add_f32 v9, v9, v21
  v_add_f32 v10, v10, v22
  v_add_f32 v11, v11, v23
  v_add_f32 v8, v8, v24
  v_add_f32 v9, v9, v25
  v_add_f32 v10, v10, v26
  v_add_f32 v11, v11, v27
  v_add_f32 v8, v8, v28
  v_add_f32 v9, v9, v29
  v_add_f32 v10, v10, v30
  v_add_f32 v11, v11, v31
  ds_read_b64 v[16:17], v5 offset:9216
  ds_read_b64 v[18:19], v5 offset:9728
  ds_read_b64 v[20:21], v5 offset:10240
  ds_read_b64 v[22:23], v5 offset:10752
  ds_read_b64 v[24:25], v5 offset:11264
  ds_read_b64 v[26:27], v5 offset:11776
  ds_read_b64 v[28:29], v5 offset:12288
  ds_read_b64 v[30:31], v5 offset:12800
  s_waitcnt lgkmcnt(0)
  v_add_f32 v8, v8, v16
  v_add_f32 v9, v9, v17
  v_add_f32 v10, v10, v18
  v_add_f32 v11, v11, v19
  v_add_f32 v8, v8, v20
  v_add_f32 v9, v9, v21
  v_add_f32 v10, v10, v22
  v_add_f32 v11, v11, v23
  v_add_f32 v8, v8, v24
  v_add_f32 v9, v9, v25
  v_add_f32 v10, v10, v26
  v_add_f32 v11, v11, v27
  v_add_f32 v8, v8, v28
  v_add_f32 v9, v9, v29
  v_add_f32 v10, v10, v30
  v_add_f32 v11, v11, v31
  ds_read_b64 v[16:17], v5 offset:13312
  ds_read_b64 v[18:19], v5 offset:13824
  ds_read_b64 v[20:21], v5 offset:14336
  ds_read_b64 v[22:23], v5 offset:14848
  ds_read_b64 v[24:25], v5 offset:15360
  ds_read_b64 v[26:27], v5 offset:15872
  s_waitcnt lgkmcnt(0)
  v_add_f32 v8, v8, v16
  v_add_f32 v9, v9, v17
  v_add_f32 v10, v10, v18
  v_add_f32 v11, v11, v19
  v_add_f32 v8, v8, v20
  v_add_f32 v9, v9, v21
  v_add_f32 v10, v10, v22
  v_add_f32 v11, v11, v23
  v_add_f32 v8, v8, v24
  v_add_f32 v9, v9, v25
  v_add_f32 v10, v10, v26
  v_add_f32 v11, v11, v27
  v_cvt_pk_bf16_f32 v8, v8, v8
  v_and_b32 v8, 0xffff0000, v8
  v_cvt_pk_bf16_f32 v9, v9, v9
  v_and_b32 v9, 0xffff0000, v9
  v_cvt_pk_bf16_f32 v10, v10, v10
  v_and_b32 v10, 0xffff0000, v10
  v_cvt_pk_bf16_f32 v11, v11, v11
  v_and_b32 v11, 0xffff0000, v11
  s_mov_b32 s16, 0x3d372713
  s_mov_b32 s17, 0xc0135761
  v_mul_f32 v16, v8, v8
  v_mul_f32 v16, s16, v16
  v_fma_f32 v16, v16, v8, v8
  v_mul_f32 v16, s17, v16
  v_min_f32 v16, 0x42fc0000, v16
  v_exp_f32 v16, v16
  s_nop 0
  v_add_f32 v16, 1.0, v16
  v_rcp_f32 v18, v16
  s_nop 0
  v_fma_f32 v20, -v16, v18, 1.0
  v_fma_f32 v18, v20, v18, v18
  v_mul_f32 v8, v8, v18
  v_cvt_pk_bf16_f32 v8, v8, v8
  v_and_b32 v8, 0xffff0000, v8
  v_mul_f32 v8, v8, v10
  v_cvt_pk_bf16_f32 v8, v8, v8
  v_and_b32 v8, 0xffff0000, v8
  v_mul_f32 v17, v9, v9
  v_mul_f32 v17, s16, v17
  v_fma_f32 v17, v17, v9, v9
  v_mul_f32 v17, s17, v17
  v_min_f32 v17, 0x42fc0000, v17
  v_exp_f32 v17, v17
  s_nop 0
  v_add_f32 v17, 1.0, v17
  v_rcp_f32 v19, v17
  s_nop 0
  v_fma_f32 v21, -v17, v19, 1.0
  v_fma_f32 v19, v21, v19, v19
  v_mul_f32 v9, v9, v19
  v_cvt_pk_bf16_f32 v9, v9, v9
  v_and_b32 v9, 0xffff0000, v9
  v_mul_f32 v9, v9, v11
  v_cvt_pk_bf16_f32 v9, v9, v9
  v_and_b32 v9, 0xffff0000, v9
  v_lshlrev_b32 v5, 5, v3
  v_lshl_add_u32 v5, v4, 2, v5
  v_add_u32 v5, 147456, v5
  ds_write_b32 v5, v8
  ds_write_b32 v5, v9 offset:16
  s_waitcnt lgkmcnt(0)
L_w_noact:
  s_barrier
  v_and_b32 v3, 255, v0
  v_lshrrev_b32 v4, 8, v0
  v_lshlrev_b32 v5, 2, v3
  v_add_u32 v5, 65536, v5
  v_lshlrev_b32 v6, 2, v4
  v_add_u32 v6, 147456, v6
  v_mov_b32 v8, 0
  v_mov_b32 v9, 0
  ds_read_b32 v16, v5 offset:0
  ds_read_b32 v24, v6 offset:0
  ds_read_b32 v17, v5 offset:1024
  ds_read_b32 v25, v6 offset:16
  ds_read_b32 v18, v5 offset:2048
  ds_read_b32 v26, v6 offset:32
  ds_read_b32 v19, v5 offset:3072
  ds_read_b32 v27, v6 offset:48
  ds_read_b32 v20, v5 offset:4096
  ds_read_b32 v28, v6 offset:64
  ds_read_b32 v21, v5 offset:5120
  ds_read_b32 v29, v6 offset:80
  ds_read_b32 v22, v5 offset:6144
  ds_read_b32 v30, v6 offset:96
  ds_read_b32 v23, v5 offset:7168
  ds_read_b32 v31, v6 offset:112
  s_waitcnt lgkmcnt(0)
  v_lshlrev_b32 v10, 16, v16
  v_and_b32 v11, 0xffff0000, v16
  v_fmac_f32 v8, v24, v10
  v_fmac_f32 v9, v24, v11
  v_lshlrev_b32 v10, 16, v17
  v_and_b32 v11, 0xffff0000, v17
  v_fmac_f32 v8, v25, v10
  v_fmac_f32 v9, v25, v11
  v_lshlrev_b32 v10, 16, v18
  v_and_b32 v11, 0xffff0000, v18
  v_fmac_f32 v8, v26, v10
  v_fmac_f32 v9, v26, v11
  v_lshlrev_b32 v10, 16, v19
  v_and_b32 v11, 0xffff0000, v19
  v_fmac_f32 v8, v27, v10
  v_fmac_f32 v9, v27, v11
  v_lshlrev_b32 v10, 16, v20
  v_and_b32 v11, 0xffff0000, v20
  v_fmac_f32 v8, v28, v10
  v_fmac_f32 v9, v28, v11
  v_lshlrev_b32 v10, 16, v21
  v_and_b32 v11, 0xffff0000, v21
  v_fmac_f32 v8, v29, v10
  v_fmac_f32 v9, v29, v11
  v_lshlrev_b32 v10, 16, v22
  v_and_b32 v11, 0xffff0000, v22
  v_fmac_f32 v8, v30, v10
  v_fmac_f32 v9, v30, v11
  v_lshlrev_b32 v10, 16, v23
  v_and_b32 v11, 0xffff0000, v23
  v_fmac_f32 v8, v31, v10
  v_fmac_f32 v9, v31, v11
  ds_read_b32 v16, v5 offset:8192
  ds_read_b32 v24, v6 offset:128
  ds_read_b32 v17, v5 offset:9216
  ds_read_b32 v25, v6 offset:144
  ds_read_b32 v18, v5 offset:10240
  ds_read_b32 v26, v6 offset:160
  ds_read_b32 v19, v5 offset:11264
  ds_read_b32 v27, v6 offset:176
  ds_read_b32 v20, v5 offset:12288
  ds_read_b32 v28, v6 offset:192
  ds_read_b32 v21, v5 offset:13312
  ds_read_b32 v29, v6 offset:208
  ds_read_b32 v22, v5 offset:14336
  ds_read_b32 v30, v6 offset:224
  ds_read_b32 v23, v5 offset:15360
  ds_read_b32 v31, v6 offset:240
  s_waitcnt lgkmcnt(0)
  v_lshlrev_b32 v10, 16, v16
  v_and_b32 v11, 0xffff0000, v16
  v_fmac_f32 v8, v24, v10
  v_fmac_f32 v9, v24, v11
  v_lshlrev_b32 v10, 16, v17
  v_and_b32 v11, 0xffff0000, v17
  v_fmac_f32 v8, v25, v10
  v_fmac_f32 v9, v25, v11
  v_lshlrev_b32 v10, 16, v18
  v_and_b32 v11, 0xffff0000, v18
  v_fmac_f32 v8, v26, v10
  v_fmac_f32 v9, v26, v11
  v_lshlrev_b32 v10, 16, v19
  v_and_b32 v11, 0xffff0000, v19
  v_fmac_f32 v8, v27, v10
  v_fmac_f32 v9, v27, v11
  v_lshlrev_b32 v10, 16, v20
  v_and_b32 v11, 0xffff0000, v20
  v_fmac_f32 v8, v28, v10
  v_fmac_f32 v9, v28, v11
  v_lshlrev_b32 v10, 16, v21
  v_and_b32 v11, 0xffff0000, v21
  v_fmac_f32 v8, v29, v10
  v_fmac_f32 v9, v29, v11
  v_lshlrev_b32 v10, 16, v22
  v_and_b32 v11, 0xffff0000, v22
  v_fmac_f32 v8, v30, v10
  v_fmac_f32 v9, v30, v11
  v_lshlrev_b32 v10, 16, v23
  v_and_b32 v11, 0xffff0000, v23
  v_fmac_f32 v8, v31, v10
  v_fmac_f32 v9, v31, v11
  ds_read_b32 v16, v5 offset:16384
  ds_read_b32 v24, v6 offset:256
  ds_read_b32 v17, v5 offset:17408
  ds_read_b32 v25, v6 offset:272
  ds_read_b32 v18, v5 offset:18432
  ds_read_b32 v26, v6 offset:288
  ds_read_b32 v19, v5 offset:19456
  ds_read_b32 v27, v6 offset:304
  ds_read_b32 v20, v5 offset:20480
  ds_read_b32 v28, v6 offset:320
  ds_read_b32 v21, v5 offset:21504
  ds_read_b32 v29, v6 offset:336
  ds_read_b32 v22, v5 offset:22528
  ds_read_b32 v30, v6 offset:352
  ds_read_b32 v23, v5 offset:23552
  ds_read_b32 v31, v6 offset:368
  s_waitcnt lgkmcnt(0)
  v_lshlrev_b32 v10, 16, v16
  v_and_b32 v11, 0xffff0000, v16
  v_fmac_f32 v8, v24, v10
  v_fmac_f32 v9, v24, v11
  v_lshlrev_b32 v10, 16, v17
  v_and_b32 v11, 0xffff0000, v17
  v_fmac_f32 v8, v25, v10
  v_fmac_f32 v9, v25, v11
  v_lshlrev_b32 v10, 16, v18
  v_and_b32 v11, 0xffff0000, v18
  v_fmac_f32 v8, v26, v10
  v_fmac_f32 v9, v26, v11
  v_lshlrev_b32 v10, 16, v19
  v_and_b32 v11, 0xffff0000, v19
  v_fmac_f32 v8, v27, v10
  v_fmac_f32 v9, v27, v11
  v_lshlrev_b32 v10, 16, v20
  v_and_b32 v11, 0xffff0000, v20
  v_fmac_f32 v8, v28, v10
  v_fmac_f32 v9, v28, v11
  v_lshlrev_b32 v10, 16, v21
  v_and_b32 v11, 0xffff0000, v21
  v_fmac_f32 v8, v29, v10
  v_fmac_f32 v9, v29, v11
  v_lshlrev_b32 v10, 16, v22
  v_and_b32 v11, 0xffff0000, v22
  v_fmac_f32 v8, v30, v10
  v_fmac_f32 v9, v30, v11
  v_lshlrev_b32 v10, 16, v23
  v_and_b32 v11, 0xffff0000, v23
  v_fmac_f32 v8, v31, v10
  v_fmac_f32 v9, v31, v11
  ds_read_b32 v16, v5 offset:24576
  ds_read_b32 v24, v6 offset:384
  ds_read_b32 v17, v5 offset:25600
  ds_read_b32 v25, v6 offset:400
  ds_read_b32 v18, v5 offset:26624
  ds_read_b32 v26, v6 offset:416
  ds_read_b32 v19, v5 offset:27648
  ds_read_b32 v27, v6 offset:432
  ds_read_b32 v20, v5 offset:28672
  ds_read_b32 v28, v6 offset:448
  ds_read_b32 v21, v5 offset:29696
  ds_read_b32 v29, v6 offset:464
  ds_read_b32 v22, v5 offset:30720
  ds_read_b32 v30, v6 offset:480
  ds_read_b32 v23, v5 offset:31744
  ds_read_b32 v31, v6 offset:496
  s_waitcnt lgkmcnt(0)
  v_lshlrev_b32 v10, 16, v16
  v_and_b32 v11, 0xffff0000, v16
  v_fmac_f32 v8, v24, v10
  v_fmac_f32 v9, v24, v11
  v_lshlrev_b32 v10, 16, v17
  v_and_b32 v11, 0xffff0000, v17
  v_fmac_f32 v8, v25, v10
  v_fmac_f32 v9, v25, v11
  v_lshlrev_b32 v10, 16, v18
  v_and_b32 v11, 0xffff0000, v18
  v_fmac_f32 v8, v26, v10
  v_fmac_f32 v9, v26, v11
  v_lshlrev_b32 v10, 16, v19
  v_and_b32 v11, 0xffff0000, v19
  v_fmac_f32 v8, v27, v10
  v_fmac_f32 v9, v27, v11
  v_lshlrev_b32 v10, 16, v20
  v_and_b32 v11, 0xffff0000, v20
  v_fmac_f32 v8, v28, v10
  v_fmac_f32 v9, v28, v11
  v_lshlrev_b32 v10, 16, v21
  v_and_b32 v11, 0xffff0000, v21
  v_fmac_f32 v8, v29, v10
  v_fmac_f32 v9, v29, v11
  v_lshlrev_b32 v10, 16, v22
  v_and_b32 v11, 0xffff0000, v22
  v_fmac_f32 v8, v30, v10
  v_fmac_f32 v9, v30, v11
  v_lshlrev_b32 v10, 16, v23
  v_and_b32 v11, 0xffff0000, v23
  v_fmac_f32 v8, v31, v10
  v_fmac_f32 v9, v31, v11
  v_lshlrev_b32 v5, 3, v0
  s_and_b32 s16, s2, 3
  s_lshl_b32 s16, s16, 13
  s_add_u32 s16, s16, 49152
  buffer_atomic_add_f32 v8, v5, s[92:95], s16 offen
  buffer_atomic_add_f32 v9, v5, s[92:95], s16 offen offset:4
  s_waitcnt vmcnt(0)
  s_barrier
  s_cmp_eq_u32 s3, 0
  s_cbranch_scc0 L_w_notick
  v_mov_b32 v8, 1
  v_mov_b32 v9, 0
  s_mov_b32 s16, 37888
  s_mov_b64 exec, 1
  buffer_atomic_add v8, v9, s[92:95], s16 offen sc0
  s_waitcnt vmcnt(0)
  v_mov_b32 v9, 147968
  ds_write_b32 v9, v8
  s_waitcnt lgkmcnt(0)
  s_mov_b64 exec, -1
L_w_notick:
  s_barrier
  v_mov_b32 v9, 147968
  ds_read_b32 v8, v9
  s_waitcnt lgkmcnt(0)
  v_readfirstlane_b32 s16, v8
  s_nop 3
  s_cmp_eq_u32 s16, 55
  s_cbranch_scc0 L_END
  v_lshlrev_b32 v5, 3, v0
  s_mov_b32 s16, 49152
  buffer_load_dwordx2 v[8:9], v5, s[92:95], s16 offen sc1
  s_mov_b32 s16, 57344
  buffer_load_dwordx2 v[16:17], v5, s[92:95], s16 offen sc1
  s_mov_b32 s16, 65536
  buffer_load_dwordx2 v[18:19], v5, s[92:95], s16 offen sc1
  s_mov_b32 s16, 73728
  buffer_load_dwordx2 v[20:21], v5, s[92:95], s16 offen sc1
  v_mul_u32_u24 v6, 6144, v4
  v_lshl_add_u32 v6, v3, 2, v6
  s_mov_b32 s16, 5120
  buffer_load_dword v10, v6, s[92:95], s16 offen sc1
  v_add_u32 v7, 98304, v5
  ds_read_b64 v[12:13], v7
  s_waitcnt vmcnt(0) lgkmcnt(0)
  v_add_f32 v8, v8, v16
  v_add_f32 v9, v9, v17
  v_add_f32 v18, v18, v20
  v_add_f32 v19, v19, v21
  v_add_f32 v8, v8, v18
  v_add_f32 v9, v9, v19
  v_lshlrev_b32 v14, 16, v10
  v_and_b32 v15, 0xffff0000, v10
  v_cvt_pk_bf16_f32 v8, v8, v8
  v_and_b32 v8, 0xffff0000, v8
  v_cvt_pk_bf16_f32 v9, v9, v9
  v_and_b32 v9, 0xffff0000, v9
  v_mul_f32 v8, v8, v14
  v_mul_f32 v9, v9, v15
  v_cvt_pk_bf16_f32 v8, v8, v8
  v_and_b32 v8, 0xffff0000, v8
  v_cvt_pk_bf16_f32 v9, v9, v9
  v_and_b32 v9, 0xffff0000, v9
  v_add_f32 v8, v8, v12
  v_add_f32 v9, v9, v13
  v_cvt_pk_bf16_f32 v8, v8, v9
  v_lshlrev_b32 v5, 2, v0
  buffer_store_dword v8, v5, s[84:87], 0 offen
L_END:
  s_endpgm
.section .rodata,"a"
.p2align 6
.amdhsa_kernel adaLN_cond__mha_block_cached__geglu_ffn__decode_kernel
  .amdhsa_next_free_vgpr 128
  .amdhsa_next_free_sgpr 102
  .amdhsa_accum_offset 128
  .amdhsa_group_segment_fixed_size 0
  .amdhsa_kernarg_size 112
  .amdhsa_user_sgpr_count 2
  .amdhsa_user_sgpr_kernarg_segment_ptr 1
  .amdhsa_system_sgpr_workgroup_id_x 1
.end_amdhsa_kernel
.amdhsa_kernel adaln_pre_kernel
  .amdhsa_next_free_vgpr 128
  .amdhsa_next_free_sgpr 102
  .amdhsa_accum_offset 128
  .amdhsa_group_segment_fixed_size 0
  .amdhsa_kernarg_size 112
  .amdhsa_user_sgpr_count 2
  .amdhsa_user_sgpr_kernarg_segment_ptr 1
  .amdhsa_system_sgpr_workgroup_id_x 1
.end_amdhsa_kernel
```
